```python
import torch

def _softmax(x, axis=-1):
    return torch.softmax(x, dim=axis)
def _gelu(x):
    return torch.nn.functional.gelu(x, approximate="tanh")
def _silu(x):
    return torch.nn.functional.silu(x)
def _sigmoid(x):
    return torch.sigmoid(x)
def _layernorm(x, axis=-1, eps=1e-5):
    m = x.mean(dim=axis, keepdim=True)
    v = x.var(dim=axis, keepdim=True, unbiased=False)
    return (x - m) / torch.sqrt(v + eps)
def _scatter_add(tgt, idx, src, axis=0):
    return tgt.clone().index_add_(axis, idx, src)
def _segment_sum(src, seg, n):
    out = torch.zeros((n,) + src.shape[1:], dtype=src.dtype)
    return out.index_add_(0, seg, src)
def _pad(x, pw):
    flat = tuple(v for pair in reversed(pw) for v in pair)
    return torch.nn.functional.pad(x, flat)

kernel_name = 'gated_mix__softmax_full_mha__ssm_conv_s4__prompt'

def setup_inputs():

    _w = (lambda a: (lambda t: t.to(torch.bfloat16) if t.is_floating_point() else t)(torch.as_tensor(a)))
    def _A_setup():
        B, S, D = 1, 2048, 512
        return {
            "x": _w((lambda *s: torch.randn(*s, dtype=torch.bfloat16) * 0.05)(B, S, D)),
            "wqkv": _w((lambda *s: torch.randn(*s, dtype=torch.bfloat16) * 0.8)(D, 3 * D)),
            "wo": _w((lambda *s: torch.randn(*s, dtype=torch.bfloat16) * 0.05)(D, D)),
        }
    _A_in = _A_setup()

    def _B_setup():
        B, L, D, N = 1, 2048, 512, 128
        A_re = -(lambda _x: torch.exp(torch.as_tensor(_x)))((lambda *s: torch.randn(*s, dtype=torch.bfloat16) * 6.4)(D, N))
        A_im = torch.pi * (lambda *s: torch.randn(*s, dtype=torch.bfloat16) * 0.1)(D, N)
        B_re = (lambda *s: torch.randn(*s, dtype=torch.bfloat16) * 0.2)(D, N)
        B_im = (lambda *s: torch.randn(*s, dtype=torch.bfloat16) * 0.2)(D, N)
        C_re = (lambda *s: torch.randn(*s, dtype=torch.bfloat16) * 0.2)(D, N)
        C_im = (lambda *s: torch.randn(*s, dtype=torch.bfloat16) * 0.2)(D, N)
        log_dt = (lambda *s: torch.randn(*s, dtype=torch.bfloat16) * 0.1)(D) * 0.5 - 4.0
        Dskip = (lambda *s: torch.randn(*s, dtype=torch.bfloat16) * 0.1)(D)
        return {
            "u": _w((lambda *s: torch.randn(*s, dtype=torch.bfloat16) * 0.05)(B, L, D)),
            "A_re": _w(A_re),
            "A_im": _w(A_im),
            "B_re": _w(B_re),
            "B_im": _w(B_im),
            "C_re": _w(C_re),
            "C_im": _w(C_im),
            "log_dt": _w(log_dt),
            "Dskip": _w(Dskip),
        }
    _B_in = _B_setup()

    return {
        "A_x": _A_in["x"],
        "A_wqkv": _A_in["wqkv"],
        "A_wo": _A_in["wo"],
        "B_u": _B_in["u"],
        "B_A_re": _B_in["A_re"],
        "B_A_im": _B_in["A_im"],
        "B_B_re": _B_in["B_re"],
        "B_B_im": _B_in["B_im"],
        "B_C_re": _B_in["C_re"],
        "B_C_im": _B_in["C_im"],
        "B_log_dt": _B_in["log_dt"],
        "B_Dskip": _B_in["Dskip"],
        "gate_w": _w((lambda *s: torch.randn(*s, dtype=torch.bfloat16) * 0.05)(512) * 16.0),
    }

def reference(A_x, A_wqkv, A_wo, B_u, B_A_re, B_A_im, B_B_re, B_B_im, B_C_re, B_C_im, B_log_dt, B_Dskip, gate_w):
    def _A_ref(x, wqkv, wo):
        B, S, D = x.shape
        H = 32; Dh = D // H
        qkv = (lambda x, *d: x.permute(*d))((x @ wqkv).reshape(B, S, 3, H, Dh), 2, 0, 3, 1, 4)
        q, k, v = qkv[0], qkv[1], qkv[2]
        scale = Dh ** -0.5
        scores = torch.einsum("bhqd,bhkd->bhqk", q, k) * scale
        p = _softmax(scores, axis=-1)
        o = torch.einsum("bhqk,bhkd->bhqd", p, v)
        return (lambda x, *d: x.permute(*d))(o, 0, 2, 1, 3).reshape(B, S, D) @ wo

    def _B_ref(u, A_re, A_im, B_re, B_im, C_re, C_im, log_dt, Dskip):
        Bsz, L, D = u.shape
        dt = torch.exp(log_dt)[:, None]
        A = A_re + 1j * A_im
        Bc = B_re + 1j * B_im
        Cc = C_re + 1j * C_im
        logdA = dt * A
        dB = dt * Bc
        l = (lambda x, dt: x.to(dt))(torch.arange(L), A_re.dtype)
        P = torch.exp(logdA[:, :, None] * l[None, None, :])
        K = torch.einsum("dn,dnl,dn->dl", Cc, P, dB).real
        L2 = 2 * L
        Kp = _pad(K, ((0, 0), (0, L)))
        up = (lambda x, *d: x.permute(*d))(u, 0, 2, 1)
        up = _pad(up, ((0, 0), (0, 0), (0, L)))
        Kf = (lambda x, axes=(-2,-1): torch.fft.rfft2(x.float(), dim=axes))(Kp[:, None, :], axes=(-2, -1))
        Uf = (lambda x, axes=(-2,-1): torch.fft.rfft2(x.float(), dim=axes))(up[:, :, None, :], axes=(-2, -1))
        Yf = Uf * Kf[None, :, :, :]
        y = (lambda x, s, axes=(-2,-1): torch.fft.irfft2(x, s=s, dim=axes).to(torch.bfloat16))(Yf, (1, L2), axes=(-2, -1))[:, :, 0, :L]
        y = (lambda x, *d: x.permute(*d))(y, 0, 2, 1) + u * Dskip[None, None, :]
        return y

    x = A_x
    g = _sigmoid((x * gate_w).sum(-1, keepdims=True))
    a = _A_ref(x, A_wqkv, A_wo)
    b = _B_ref(x, B_A_re, B_A_im, B_B_re, B_B_im, B_C_re, B_C_im, B_log_dt, B_Dskip)
    return g * a + (1 - g) * b
```

```asm
; @launch grid=(256,1,1) block=(512,1,1) lds=163840
.amdgcn_target "amdgcn-amd-amdhsa--gfx950"
.text
.globl gated_mix__softmax_full_mha__ssm_conv_s4__prompt_kernel
.p2align 8
.type gated_mix__softmax_full_mha__ssm_conv_s4__prompt_kernel,@function
gated_mix__softmax_full_mha__ssm_conv_s4__prompt_kernel:
    s_cmp_ge_u32 s2, 256
    s_cbranch_scc1 L_end
    s_load_dwordx4 s[4:7], s[0:1], 0
    s_load_dwordx8 s[36:43], s[0:1], 32
    s_load_dwordx8 s[44:51], s[0:1], 64
    s_load_dwordx2 s[58:59], s[0:1], 120
    s_load_dwordx4 s[52:55], s[0:1], 96
    s_load_dwordx2 s[56:57], s[0:1], 16
    s_getpc_b64 s[28:29]
A_pc:
    v_lshlrev_b32 v1, 7, v0
    v_cmp_gt_u32 vcc, L_codeend-A_pc-4, v1
    s_nop 1
    s_and_saveexec_b64 s[30:31], vcc
    s_cbranch_execz A_nopf
    global_load_dword v254, v1, s[28:29]
A_nopf:
    s_mov_b64 exec, -1
    v_lshrrev_b32 v1, 6, v0
    v_and_b32 v0, 63, v0
    v_readfirstlane_b32 s3, v1
    s_and_b32 s30, s2, 7
    s_bfe_u32 s31, s2, 0x20003
    s_lshr_b32 s64, s2, 5
    s_and_b32 s61, s30, 1
    s_lshl_b32 s61, s61, 2
    s_add_u32 s61, s61, s31
    s_lshr_b32 s62, s30, 1
    s_lshl_b32 s62, s62, 3
    s_add_u32 s62, s62, s64
    s_lshl_b32 s63, s30, 2
    s_add_u32 s63, s63, s31
    s_and_b32 s67, s3, 3
    s_lshr_b32 s68, s3, 2
    s_lshl_b32 s69, s63, 4
    s_lshl_b32 s32, s64, 1
    s_add_u32 s69, s69, s32
    s_lshr_b32 s66, s67, 1
    s_and_b32 s35, s67, 1
    s_cmp_ge_u32 s3, 4
    s_cbranch_scc1 H_first
    s_mov_b32 s72, 0
    s_add_u32 s34, s69, s66
    s_lshl_b32 s32, s34, 8
    s_lshl_b32 s33, s35, 7
    s_add_u32 s32, s32, s33
    v_lshl_add_u32 v1, v0, 1, s32
    s_lshl_b32 s33, s34, 1
    v_mov_b32 v2, s33
    v_mov_b32 v20, 0
    v_mov_b32 v21, 0
    v_mov_b32 v22, 0
    v_mov_b32 v23, 0
    v_mov_b32 v24, 0
    v_mov_b32 v25, 0
    v_mov_b32 v26, 0
    v_mov_b32 v27, 0
    s_waitcnt lgkmcnt(0)
    global_load_short_d16_hi v26, v2, s[48:49]
    global_load_short_d16_hi v20, v1, s[36:37]
    global_load_short_d16_hi v21, v1, s[38:39]
    global_load_short_d16_hi v22, v1, s[40:41]
    global_load_short_d16_hi v23, v1, s[42:43]
    global_load_short_d16_hi v24, v1, s[44:45]
    global_load_short_d16_hi v25, v1, s[46:47]
    global_load_short_d16_hi v27, v2, s[50:51]
    s_branch A_compute
H_first:
    s_mov_b32 s72, 1
    s_lshl_b32 s32, s62, 16
    s_lshl_b32 s33, s61, 7
    s_lshl_b32 s29, s67, 5
    s_xor_b32 s28, s33, 512
    s_add_u32 s29, s29, s28
    s_add_u32 s29, s29, s32
    s_lshl_b32 s28, s67, 11
    s_add_u32 m0, s28, 24576
    v_lshrrev_b32 v1, 1, v0
    v_lshlrev_b32 v5, 10, v1
    v_and_b32 v2, 1, v0
    v_lshl_add_u32 v5, v2, 4, v5
    v_add_u32 v6, 31744, v5
    s_lshl_b32 s34, s31, 1
    s_add_u32 s34, s34, s62
    s_lshr_b32 s28, s61, 2
    s_add_u32 s34, s34, s28
    s_and_b32 s34, s34, 7
    s_lshl_b32 s28, s67, 14
    s_add_u32 s32, s32, s28
    s_mul_i32 s28, s67, 49152
    s_add_u32 s33, s33, s28
    v_lshrrev_b32 v1, 3, v0
    v_and_b32 v3, 7, v0
    v_lshrrev_b32 v4, 4, v0
    v_xor_b32 v7, v3, v4
    v_lshlrev_b32 v2, 10, v1
    v_lshl_add_u32 v56, v7, 4, v2
    v_xor_b32 v57, 64, v56
    v_add_u32 v57, 7168, v57
    v_and_b32 v4, 1, v4
    v_lshlrev_b32 v4, 2, v4
    v_xor_b32 v7, v3, v4
    v_mul_u32_u24 v2, 3072, v1
    v_lshl_add_u32 v58, v7, 4, v2
    s_waitcnt lgkmcnt(0)
    s_mov_b32 s8, s4
    s_mov_b32 s9, s5
    s_mov_b32 s10, 0x200000
    s_mov_b32 s11, 0x00020000
    buffer_load_dwordx4 v5, s[8:11], s29 offen lds
    buffer_load_dwordx4 v6, s[8:11], s29 offen offset:1024 lds
    s_mov_b32 s12, s6
    s_mov_b32 s13, s7
    s_mov_b32 s14, 0x180000
    s_mov_b32 s15, 0x00020000
    s_lshl_b32 s50, s67, 11
    s_mul_i32 s51, s67, 6144
    s_lshl_b32 s4, s34, 7
    s_add_u32 s4, s4, s32
    s_add_u32 m0, s50, 0
    s_mul_i32 s5, s34, 196608
    buffer_load_dwordx4 v56, s[8:11], s4 offen offset:0 lds
    buffer_load_dwordx4 v57, s[8:11], s4 offen offset:1024 lds
    s_add_u32 s5, s5, s33
    s_add_u32 m0, s51, 32768
    s_add_u32 s34, s34, 1
    buffer_load_dwordx4 v58, s[12:15], s5 offen offset:0 lds
    buffer_load_dwordx4 v58, s[12:15], s5 offen offset:1024 lds
    buffer_load_dwordx4 v58, s[12:15], s5 offen offset:2048 lds
    s_add_u32 s5, s5, 24576
    s_add_u32 m0, s51, 35840
    s_and_b32 s34, s34, 7
    buffer_load_dwordx4 v58, s[12:15], s5 offen offset:0 lds
    buffer_load_dwordx4 v58, s[12:15], s5 offen offset:1024 lds
    buffer_load_dwordx4 v58, s[12:15], s5 offen offset:2048 lds
    s_lshl_b32 s4, s34, 7
    s_add_u32 s4, s4, s32
    s_add_u32 m0, s50, 8192
    s_mul_i32 s5, s34, 196608
    buffer_load_dwordx4 v56, s[8:11], s4 offen offset:0 lds
    buffer_load_dwordx4 v57, s[8:11], s4 offen offset:1024 lds
    s_mov_b32 s28, 15794176
    s_load_dword s60, s[58:59], s28
    s_mov_b32 s16, s58
    s_mov_b32 s17, s59
    s_mov_b32 s18, 0x1000000
    s_mov_b32 s19, 0x00020000
    v_lshlrev_b32 v224, 4, v0
    s_add_u32 s28, s50, 24576
    v_lshrrev_b32 v4, 4, v0
    v_and_b32 v7, 15, v0
    v_lshlrev_b32 v5, 8, v4
    v_lshl_add_u32 v5, v7, 3, v5
    v_add_u32 v5, s28, v5
    s_xor_b32 s65, s61, 4
    s_lshl_b32 s65, s65, 2
    s_add_u32 s65, s65, s67
    s_lshl_b32 s6, s65, 16
    s_lshl_b32 s7, s62, 11
    s_add_u32 s6, s6, s7
    s_add_u32 s6, s6, 12582912
    s_lshl_b32 s65, s65, 7
    s_lshl_b32 s28, s62, 2
    s_add_u32 s65, s65, s28
    s_add_u32 s65, s65, 15798272
    s_add_u32 s5, s5, s33
    s_add_u32 m0, s51, 57344
    s_add_u32 s34, s34, 1
    buffer_load_dwordx4 v58, s[12:15], s5 offen offset:0 lds
    s_mov_b32 s20, s54
    s_mov_b32 s21, s55
    s_mov_b32 s22, 0x200000
    s_mov_b32 s23, 0x00020000
    s_mov_b32 s24, s56
    s_mov_b32 s25, s57
    s_mov_b32 s26, 0x80000
    s_mov_b32 s27, 0x00020000
    buffer_load_dwordx4 v58, s[12:15], s5 offen offset:1024 lds
    v_and_b32 v242, 31, v0
    v_lshrrev_b32 v243, 5, v0
    s_lshl_b32 s28, s63, 7
    s_add_u32 s28, s28, 15798272
    v_lshl_add_u32 v59, v242, 2, s28
    s_lshl_b32 s28, s67, 7
    v_add_u32 v1, s28, v0
    v_add_u32 v1, 0, v1
    s_waitcnt vmcnt(12)
    ds_read_b64_tr_b16 v[12:13], v5 offset:0
    ds_read_b64_tr_b16 v[14:15], v5 offset:128
    ds_read_b64_tr_b16 v[16:17], v5 offset:1024
    ds_read_b64_tr_b16 v[18:19], v5 offset:1152
    buffer_load_dwordx4 v58, s[12:15], s5 offen offset:2048 lds
    v_mul_u32_u24 v2, 7282, v1
    v_lshrrev_b32 v2, 16, v2
    v_sub_u32 v1, v1, v2
    v_lshrrev_b32 v2, 1, v1
    v_lshlrev_b32 v2, 8, v2
    v_and_b32 v1, 1, v1
    v_lshl_add_u32 v53, v1, 4, v2
    v_add_u32 v1, s28, v0
    s_add_u32 s5, s5, 24576
    s_add_u32 m0, s51, 60416
    s_and_b32 s34, s34, 7
    buffer_load_dwordx4 v58, s[12:15], s5 offen offset:0 lds
    v_add_u32 v1, 64, v1
    v_mul_u32_u24 v2, 7282, v1
    v_lshrrev_b32 v2, 16, v2
    v_sub_u32 v1, v1, v2
    v_lshrrev_b32 v2, 1, v1
    v_lshlrev_b32 v2, 8, v2
    v_and_b32 v1, 1, v1
    v_lshl_add_u32 v54, v1, 4, v2
    s_waitcnt lgkmcnt(0)
    buffer_store_dwordx4 v[12:15], v224, s[16:19], s6 offen sc1
    buffer_store_dwordx4 v[16:19], v224, s[16:19], s6 offen offset:1024 sc1
    s_mul_i32 s60, s60, 0x9E3779B1
    s_add_u32 s60, s60, 0x7F4A7C15
    buffer_load_dwordx4 v58, s[12:15], s5 offen offset:1024 lds
    v_add_u32 v1, s28, v0
    v_add_u32 v1, 128, v1
    v_mul_u32_u24 v2, 7282, v1
    v_lshrrev_b32 v2, 16, v2
    v_sub_u32 v1, v1, v2
    v_lshrrev_b32 v2, 1, v1
    v_lshlrev_b32 v2, 8, v2
    v_and_b32 v1, 1, v1
    buffer_load_dwordx4 v58, s[12:15], s5 offen offset:2048 lds
    v_lshl_add_u32 v55, v1, 4, v2
    v_lshlrev_b32 v1, 4, v242
    s_mul_i32 s28, s66, 8576
    s_mul_i32 s29, s35, 4284
    s_add_u32 s28, s28, s29
    s_add_u32 s28, s28, 141312
    v_lshl_add_u32 v60, v243, 3, v1
    v_sub_u32 v60, 3576, v60
    s_lshl_b32 s4, s34, 7
    s_add_u32 s4, s4, s32
    s_add_u32 m0, s50, 16384
    s_mul_i32 s5, s34, 196608
    buffer_load_dwordx4 v56, s[8:11], s4 offen offset:0 lds
    v_lshl_add_u32 v61, v243, 9, v1
    v_sub_u32 v61, 3056, v61
    v_lshl_add_u32 v62, v243, 10, v1
    v_sub_u32 v62, 1520, v62
    v_add_u32 v60, s28, v60
    v_add_u32 v61, s28, v61
    v_add_u32 v62, s28, v62
    v_lshl_add_u32 v63, v0, 2, s28
    buffer_load_dwordx4 v57, s[8:11], s4 offen offset:1024 lds
    s_lshl_b32 s28, s66, 13
    s_add_u32 s28, s28, 106496
    v_add_u32 v169, s28, v224
    s_mul_i32 s28, s68, 8576
    s_lshl_b32 s29, s67, 9
    s_add_u32 s28, s28, s29
    s_add_u32 s28, s28, 141312
    v_lshlrev_b32 v1, 3, v243
    s_add_u32 s5, s5, s33
    s_add_u32 m0, s51, 81920
    s_add_u32 s34, s34, 1
    buffer_load_dwordx4 v58, s[12:15], s5 offen offset:0 lds
    v_sub_u32 v1, v1, v242
    v_add_u32 v1, 31, v1
    v_and_b32 v2, 1, v1
    v_lshrrev_b32 v1, 1, v1
    v_lshlrev_b32 v1, 2, v1
    v_mul_u32_u24 v2, 4288, v2
    v_add3_u32 v225, v1, v2, s28
    v_add_u32 v226, 2048, v225
    buffer_load_dwordx4 v58, s[12:15], s5 offen offset:1024 lds
    s_lshl_b32 s28, s68, 4
    s_mul_i32 s29, s67, 1152
    s_add_u32 s28, s28, s29
    s_add_u32 s28, s28, 126608
    v_mul_u32_u24 v1, 144, v242
    v_lshl_add_u32 v1, v243, 5, v1
    v_add_u32 v227, s28, v1
    s_lshl_b32 s28, s67, 3
    buffer_load_dwordx4 v58, s[12:15], s5 offen offset:2048 lds
    s_sub_u32 s28, 31, s28
    s_lshl_b32 s36, -1, s28
    s_mov_b32 s37, s36
    s_bfe_u32 s38, s3, 0x10001
    s_lshl_b32 s38, s38, 16
    s_lshl_b32 s28, s35, 10
    s_add_u32 s38, s38, s28
    s_lshl_b32 s39, s63, 17
    s_add_u32 s5, s5, 24576
    s_add_u32 m0, s51, 84992
    s_and_b32 s34, s34, 7
    buffer_load_dwordx4 v58, s[12:15], s5 offen offset:0 lds
    s_add_u32 s39, s39, s38
    s_add_u32 s39, s39, 2097152
    s_lshl_b32 s28, s68, 11
    s_add_u32 s28, s28, 8192
    s_add_u32 s40, s38, s28
    s_add_u32 s41, s39, s28
    s_lshl_b32 s28, s68, 16
    v_add_u32 v232, s28, v224
    buffer_load_dwordx4 v58, s[12:15], s5 offen offset:1024 lds
    s_lshl_b32 s29, s67, 11
    s_add_u32 s29, s29, 28672
    v_add_u32 v228, s29, v232
    s_lshl_b32 s29, s67, 13
    s_add_u32 s29, s29, 28672
    v_add_u32 v229, s29, v232
    s_lshl_b32 s29, s67, 10
    v_add_u32 v230, s29, v232
    buffer_load_dwordx4 v58, s[12:15], s5 offen offset:2048 lds
    v_xor_b32 v231, 0x10000, v230
    v_mov_b32 v233, 0xdddd
    s_mov_b32 s30, 0x0000ffff
    s_mov_b32 s31, 0x0000ffff
    v_mov_b32 v1, 0x3f803f80
    v_and_b32 v2, 0x1b, v0
    v_cmp_eq_u32 vcc, 16, v2
    s_lshl_b32 s28, s64, 3
    s_waitcnt vmcnt(18)
    s_barrier
    s_lshl_b32 s4, s34, 7
    s_add_u32 s4, s4, s32
    s_add_u32 m0, s50, 24576
    s_mul_i32 s5, s34, 196608
    buffer_load_dwordx4 v56, s[8:11], s4 offen offset:0 lds
    s_lshl_b32 s29, s67, 1
    v_cndmask_b32 v234, 0, v1, vcc
    s_add_u32 s28, s28, s29
    s_lshl_b32 s45, s28, 10
    s_lshl_b32 s29, s63, 16
    s_add_u32 s45, s45, s29
    s_add_u32 s28, s28, s68
    s_lshl_b32 s43, s28, 15
    buffer_load_dwordx4 v57, s[8:11], s4 offen offset:1024 lds
    s_lshl_b32 s29, s63, 10
    s_add_u32 s43, s43, s29
    s_add_u32 s43, s43, 6291456
    v_lshlrev_b32 v1, 5, v242
    v_lshl_add_u32 v235, v243, 4, v1
    s_add_u32 s44, s69, s68
    s_lshl_b32 s44, s44, 12
    s_lshl_b32 s29, s67, 10
    s_add_u32 s5, s5, s33
    s_add_u32 m0, s51, 106496
    s_add_u32 s34, s34, 1
    buffer_load_dwordx4 v58, s[12:15], s5 offen offset:0 lds
    s_add_u32 s44, s44, s29
    s_add_u32 s44, s44, 8388608
    v_lshrrev_b32 v1, 3, v0
    v_lshlrev_b32 v1, 10, v1
    v_and_b32 v2, 7, v0
    v_lshl_add_u32 v237, v2, 4, v1
    v_add_u32 v238, 7168, v237
    v_add_u32 v239, 14336, v237
    buffer_load_dwordx4 v58, s[12:15], s5 offen offset:1024 lds
    v_add_u32 v240, 21504, v237
    s_lshl_b32 s42, s3, 12
    s_add_u32 s42, s42, 131072
    s_lshl_b32 s47, s67, 17
    s_lshl_b32 s28, s64, 7
    s_add_u32 s47, s47, s28
    s_lshl_b32 s29, s67, 5
    s_add_u32 s28, s28, s29
    s_waitcnt vmcnt(12)
    s_barrier
    s_waitcnt vmcnt(14)
    v_mov_b32 v10, 0
    v_mov_b32 v11, s60
    s_mov_b64 exec, 1
    buffer_store_dword v11, v10, s[16:19], s65 offen sc1
    s_mov_b64 exec, -1
    buffer_load_dwordx4 v58, s[12:15], s5 offen offset:2048 lds
    v_lshl_add_u32 v1, v2, 2, s28
    s_lshl_b32 s28, s63, 5
    v_lshl_add_u32 v241, v2, 2, s28
    v_cmp_gt_u32 vcc, 16, v0
    s_lshl_b32 s28, s67, 8
    s_and_b32 s29, s63, 28
    v_cndmask_b32 v241, v1, v241, vcc
    s_add_u32 s28, s28, s29
    s_add_u32 s5, s5, 24576
    s_add_u32 m0, s51, 109568
    s_and_b32 s34, s34, 7
    buffer_load_dwordx4 v58, s[12:15], s5 offen offset:0 lds
    v_lshl_add_u32 v1, v2, 5, s28
    v_cmp_gt_u32 vcc, 32, v0
    s_lshl_b32 s46, s63, 1
    s_add_u32 s46, s46, s68
    v_cndmask_b32 v241, v1, v241, vcc
    v_add_u32 v241, 15806464, v241
    v_lshlrev_b32 v1, 9, v243
    v_bfe_u32 v2, v0, 2, 2
    buffer_load_dwordx4 v58, s[12:15], s5 offen offset:1024 lds
    v_lshl_add_u32 v1, v2, 7, v1
    v_bfe_u32 v2, v0, 4, 1
    v_lshl_add_u32 v1, v2, 5, v1
    v_and_b32 v2, 3, v0
    v_lshl_add_u32 v1, v2, 3, v1
    v_add_u32 v236, s42, v1
    v_and_b32 v1, 15, v0
    v_lshlrev_b32 v1, 12, v1
    buffer_load_dwordx4 v58, s[12:15], s5 offen offset:2048 lds
    v_lshl_add_u32 v244, v243, 4, v1
    v_lshlrev_b32 v1, 10, v242
    v_lshl_add_u32 v245, v243, 4, v1
    v_lshrrev_b32 v1, 3, v242
    v_bfe_u32 v2, v0, 1, 1
    v_lshl_add_u32 v1, v1, 1, v2
    v_bfe_u32 v2, v0, 2, 1
    v_xor_b32 v2, v2, v243
    s_lshl_b32 s4, s34, 7
    s_add_u32 s4, s4, s32
    s_add_u32 m0, s50, 131072
    s_mul_i32 s5, s34, 196608
    buffer_load_dwordx4 v56, s[8:11], s4 offen offset:0 lds
    v_lshl_add_u32 v1, v2, 4, v1
    v_and_b32 v2, 1, v0
    v_lshlrev_b32 v2, 4, v2
    v_mov_b32 v253, 0x3f80
    v_lshlrev_b32 v2, v2, v253
    s_mov_b32 s70, 0
    s_lshl_b32 s54, s46, 7
    s_add_u32 s54, s54, 15728640
    buffer_load_dwordx4 v57, s[8:11], s4 offen offset:1024 lds
    s_lshl_b32 s55, s64, 18
    s_lshl_b32 s29, s67, 16
    s_add_u32 s55, s55, s29
    s_and_b32 s29, s46, 31
    s_lshl_b32 s29, s29, 5
    s_add_u32 s55, s55, s29
    s_lshr_b32 s29, s46, 5
    s_lshl_b32 s29, s29, 11
    s_waitcnt vmcnt(11)
    s_barrier
    s_add_u32 s5, s5, s33
    s_add_u32 m0, s51, 139264
    s_add_u32 s34, s34, 1
    buffer_load_dwordx4 v58, s[12:15], s5 offen offset:0 lds
    s_add_u32 s55, s55, s29
    s_add_u32 s55, s55, 8388608
    s_lshl_b32 s57, s46, 15
    s_lshl_b32 s29, s67, 13
    s_add_u32 s56, s57, s29
    s_add_u32 s56, s56, 6291456
    s_lshl_b32 s29, s64, 7
    s_add_u32 s57, s57, s29
    buffer_load_dwordx4 v58, s[12:15], s5 offen offset:1024 lds
    s_lshl_b32 s29, s67, 5
    s_add_u32 s57, s57, s29
    s_lshr_b32 s28, s63, 1
    s_lshl_b32 s28, s28, 8
    s_add_u32 s28, s28, 15802368
    v_lshl_add_u32 v255, v0, 2, s28
    v_cmp_eq_u32 vcc, 0, v1
    v_cmp_eq_u32 s[28:29], 1, v1
    buffer_load_dwordx4 v58, s[12:15], s5 offen offset:2048 lds
    s_nop 0
    v_cndmask_b32 v246, 0, v2, vcc
    v_cndmask_b32 v247, 0, v2, s[28:29]
    v_cmp_eq_u32 vcc, 2, v1
    v_cmp_eq_u32 s[28:29], 3, v1
    s_nop 0
    v_cndmask_b32 v248, 0, v2, vcc
    v_cndmask_b32 v249, 0, v2, s[28:29]
    s_add_u32 s5, s5, 24576
    s_add_u32 m0, s51, 142336
    s_and_b32 s34, s34, 7
    buffer_load_dwordx4 v58, s[12:15], s5 offen offset:0 lds
    v_cmp_eq_u32 vcc, 4, v1
    v_cmp_eq_u32 s[28:29], 5, v1
    s_nop 0
    v_cndmask_b32 v250, 0, v2, vcc
    v_cndmask_b32 v251, 0, v2, s[28:29]
    v_cmp_eq_u32 vcc, 6, v1
    v_cmp_eq_u32 s[28:29], 7, v1
    s_nop 0
    buffer_load_dwordx4 v58, s[12:15], s5 offen offset:1024 lds
    v_cndmask_b32 v252, 0, v2, vcc
    v_cndmask_b32 v253, 0, v2, s[28:29]
    v_mov_b32 v152, 0
    v_mov_b32 v153, 0
    v_mov_b32 v154, 0
    v_mov_b32 v155, 0
    v_mov_b32 v176, 0
    v_mov_b32 v177, 0
    buffer_load_dwordx4 v58, s[12:15], s5 offen offset:2048 lds
    v_mov_b32 v178, 0
    v_mov_b32 v179, 0
    v_mov_b32 v192, 0
    v_mov_b32 v193, 0
    v_mov_b32 v194, 0
    v_mov_b32 v195, 0
    v_mov_b32 v208, 0
    v_mov_b32 v209, 0
    s_waitcnt vmcnt(8)
    s_barrier
    s_lshl_b32 s4, s34, 7
    s_add_u32 s4, s4, s32
    s_add_u32 m0, s50, 0
    s_mul_i32 s5, s34, 196608
    buffer_load_dwordx4 v56, s[8:11], s4 offen offset:0 lds
    v_mov_b32 v210, 0
    v_mov_b32 v211, 0
    v_mov_b32 v132, v234
    v_mov_b32 v133, v234
    v_mov_b32 v134, v234
    v_mov_b32 v135, v234
    v_mov_b32 v136, v234
    v_mov_b32 v137, v234
    buffer_load_dwordx4 v57, s[8:11], s4 offen offset:1024 lds
    v_mov_b32 v138, v234
    v_mov_b32 v139, v234
    v_mov_b32 v144, v234
    v_mov_b32 v145, v234
    v_mov_b32 v146, v234
    v_mov_b32 v147, v234
    v_mov_b32 v148, v234
    v_mov_b32 v149, v234
    s_add_u32 s5, s5, s33
    s_add_u32 m0, s51, 32768
    s_add_u32 s34, s34, 1
    buffer_load_dwordx4 v58, s[12:15], s5 offen offset:0 lds
    v_mov_b32 v150, v234
    v_mov_b32 v151, v234
    v_mov_b32 v64, 0
    v_mov_b32 v65, 0
    v_mov_b32 v66, 0
    v_mov_b32 v67, 0
    v_mov_b32 v68, 0
    v_mov_b32 v69, 0
    buffer_load_dwordx4 v58, s[12:15], s5 offen offset:1024 lds
    v_mov_b32 v70, 0
    v_mov_b32 v71, 0
    v_mov_b32 v72, 0
    v_mov_b32 v73, 0
    v_mov_b32 v74, 0
    v_mov_b32 v75, 0
    v_mov_b32 v76, 0
    v_mov_b32 v77, 0
    buffer_load_dwordx4 v58, s[12:15], s5 offen offset:2048 lds
    v_mov_b32 v78, 0
    v_mov_b32 v79, 0
    v_mov_b32 v80, 0
    v_mov_b32 v81, 0
    v_mov_b32 v82, 0
    v_mov_b32 v83, 0
    v_mov_b32 v84, 0
    v_mov_b32 v85, 0
    s_add_u32 s5, s5, 24576
    s_add_u32 m0, s51, 35840
    s_and_b32 s34, s34, 7
    buffer_load_dwordx4 v58, s[12:15], s5 offen offset:0 lds
    v_mov_b32 v86, 0
    v_mov_b32 v87, 0
    v_mov_b32 v88, 0
    v_mov_b32 v89, 0
    v_mov_b32 v90, 0
    v_mov_b32 v91, 0
    v_mov_b32 v92, 0
    v_mov_b32 v93, 0
    buffer_load_dwordx4 v58, s[12:15], s5 offen offset:1024 lds
    v_mov_b32 v94, 0
    v_mov_b32 v95, 0
    v_mov_b32 v96, 0
    v_mov_b32 v97, 0
    v_mov_b32 v98, 0
    v_mov_b32 v99, 0
    v_mov_b32 v100, 0
    v_mov_b32 v101, 0
    s_waitcnt vmcnt(7)
    s_barrier
    buffer_load_dwordx4 v58, s[12:15], s5 offen offset:2048 lds
    v_mov_b32 v102, 0
    v_mov_b32 v103, 0
    v_mov_b32 v104, 0
    v_mov_b32 v105, 0
    v_mov_b32 v106, 0
    v_mov_b32 v107, 0
    v_mov_b32 v108, 0
    v_mov_b32 v109, 0
    s_lshl_b32 s4, s34, 7
    s_add_u32 s4, s4, s32
    s_add_u32 m0, s50, 8192
    s_mul_i32 s5, s34, 196608
    buffer_load_dwordx4 v56, s[8:11], s4 offen offset:0 lds
    v_mov_b32 v110, 0
    v_mov_b32 v111, 0
    v_mov_b32 v112, 0
    v_mov_b32 v113, 0
    v_mov_b32 v114, 0
    v_mov_b32 v115, 0
    v_mov_b32 v116, 0
    v_mov_b32 v117, 0
    buffer_load_dwordx4 v57, s[8:11], s4 offen offset:1024 lds
    v_mov_b32 v118, 0
    v_mov_b32 v119, 0
    v_mov_b32 v120, 0
    v_mov_b32 v121, 0
    v_mov_b32 v122, 0
    v_mov_b32 v123, 0
    v_mov_b32 v124, 0
    v_mov_b32 v125, 0
    s_add_u32 s5, s5, s33
    s_add_u32 m0, s51, 57344
    s_add_u32 s34, s34, 1
    buffer_load_dwordx4 v58, s[12:15], s5 offen offset:0 lds
    v_mov_b32 v126, 0
    v_mov_b32 v127, 0
    buffer_load_dwordx4 v58, s[12:15], s5 offen offset:1024 lds
    buffer_load_dwordx4 v58, s[12:15], s5 offen offset:2048 lds
    s_add_u32 s5, s5, 24576
    s_add_u32 m0, s51, 60416
    s_and_b32 s34, s34, 7
    buffer_load_dwordx4 v58, s[12:15], s5 offen offset:0 lds
    buffer_load_dwordx4 v58, s[12:15], s5 offen offset:1024 lds
    s_waitcnt vmcnt(7)
    s_barrier
    buffer_load_dword v3, v59, s[16:19], 0 offen sc1
    buffer_load_dwordx4 v58, s[12:15], s5 offen offset:2048 lds
    s_lshl_b32 s4, s34, 7
    s_add_u32 s4, s4, s32
    s_add_u32 m0, s50, 16384
    s_mul_i32 s5, s34, 196608
    buffer_load_dwordx4 v56, s[8:11], s4 offen offset:0 lds
    buffer_load_dwordx4 v57, s[8:11], s4 offen offset:1024 lds
    s_add_u32 s5, s5, s33
    s_add_u32 m0, s51, 81920
    s_add_u32 s34, s34, 1
    buffer_load_dwordx4 v58, s[12:15], s5 offen offset:0 lds
    buffer_load_dwordx4 v58, s[12:15], s5 offen offset:1024 lds
    buffer_load_dwordx4 v58, s[12:15], s5 offen offset:2048 lds
    s_add_u32 s5, s5, 24576
    s_add_u32 m0, s51, 84992
    s_and_b32 s34, s34, 7
    buffer_load_dwordx4 v58, s[12:15], s5 offen offset:0 lds
    buffer_load_dwordx4 v58, s[12:15], s5 offen offset:1024 lds
    buffer_load_dwordx4 v58, s[12:15], s5 offen offset:2048 lds
    s_waitcnt vmcnt(8)
    s_barrier
    s_waitcnt vmcnt(9)
    v_cmp_ne_u32 vcc, s60, v3
    s_cbranch_vccz H_uok
    s_mov_b32 s71, 200000
SP1:
    s_sleep 2
    buffer_load_dword v3, v59, s[16:19], 0 offen sc1
SP1_chk:
    s_waitcnt vmcnt(0)
    v_cmp_ne_u32 vcc, s60, v3
    s_sub_u32 s71, s71, 1
    s_nop 0
    s_cselect_b64 vcc, 0, vcc
    s_cbranch_vccnz SP1
H_uok:
    s_lshl_b32 s29, s63, 16
    s_lshl_b32 s28, s64, 5
    s_add_u32 s29, s29, s28
    s_add_u32 s29, s29, 12582912
    s_add_u32 s28, s50, 131072
    v_add_u32 v59, s28, v224
    buffer_load_dwordx4 v[156:159], v53, s[16:19], s29 offen sc1
    buffer_load_dwordx4 v[160:163], v54, s[16:19], s29 offen sc1
    buffer_load_dwordx4 v[164:167], v55, s[16:19], s29 offen sc1
    s_waitcnt vmcnt(3)
    s_barrier
    v_mov_b32 v1, 0
    v_mov_b32 v2, 159744
    ds_write_b32 v2, v1
    s_barrier
    ds_read_b128 v[4:7], v169 offset:0
    ds_read_b128 v[8:11], v169 offset:1024
    ds_read_b128 v[12:15], v169 offset:2048
    ds_read_b128 v[16:19], v169 offset:3072
    ds_read_b128 v[20:23], v169 offset:4096
    ds_read_b128 v[24:27], v169 offset:5120
    ds_read_b128 v[28:31], v169 offset:6144
    ds_read_b128 v[32:35], v169 offset:7168
    v_and_b32 v1, 1, v0
    v_cmp_eq_u32 vcc, 0, v1
    v_cmp_eq_u32 s[28:29], 0, v0
    s_waitcnt lgkmcnt(0)
    v_add_f32 v4, v4, v20
    v_add_f32 v5, v5, v21
    v_add_f32 v6, v6, v22
    v_add_f32 v7, v7, v23
    v_add_f32 v8, v8, v24
    v_add_f32 v9, v9, v25
    v_add_f32 v10, v10, v26
    v_add_f32 v11, v11, v27
    v_add_f32 v12, v12, v28
    v_add_f32 v13, v13, v29
    v_add_f32 v14, v14, v30
    v_add_f32 v15, v15, v31
    v_add_f32 v16, v16, v32
    v_add_f32 v17, v17, v33
    v_add_f32 v18, v18, v34
    v_cndmask_b32 v1, v15, v14, vcc
    v_cndmask_b32 v2, v17, v16, vcc
    s_cmp_lg_u32 s35, 0
    s_cbranch_scc1 R_c1
    v_mov_b32 v52, 0
    v_cvt_pk_bf16_f32 v36, v7, v6
    v_cvt_pk_bf16_f32 v37, v5, v4
    v_cvt_pk_bf16_f32 v38, v10, v9
    v_cvt_pk_bf16_f32 v39, v8, v8
    ds_write_b64 v60, v[36:37] offset:512
    ds_write_b64 v60, v[38:39]
    v_cvt_pk_bf16_f32 v40, v13, v13
    v_cvt_pk_bf16_f32 v41, v12, v12
    v_cvt_pk_bf16_f32 v42, v12, v11
    v_cvt_pk_bf16_f32 v43, v11, v11
    ds_write_b128 v61, v[40:43]
    v_cvt_pk_bf16_f32 v44, v15, v15
    v_cvt_pk_bf16_f32 v45, v15, v1
    v_cvt_pk_bf16_f32 v46, v14, v14
    v_mov_b32 v47, v46
    ds_write_b128 v62, v[44:47] offset:512
    v_cvt_pk_bf16_f32 v48, v17, v17
    v_cvt_pk_bf16_f32 v49, v17, v2
    v_cvt_pk_bf16_f32 v50, v16, v16
    v_mov_b32 v51, v50
    ds_write_b128 v62, v[48:51]
    s_branch R_e
R_c1:
    v_cvt_pk_bf16_f32 v36, v18, v7
    v_cvt_pk_bf16_f32 v37, v6, v5
    ds_write2_b32 v60, v36, v37 offset0:128 offset1:129
    v_cvt_pk_bf16_f32 v38, v10, v10
    v_cvt_pk_bf16_f32 v39, v9, v8
    ds_write2_b32 v60, v38, v39 offset0:0 offset1:1
    v_cvt_pk_bf16_f32 v40, v13, v13
    v_cvt_pk_bf16_f32 v41, v13, v12
    ds_write2_b32 v61, v40, v41 offset0:0 offset1:1
    v_cvt_pk_bf16_f32 v42, v12, v12
    v_cvt_pk_bf16_f32 v43, v11, v11
    ds_write2_b32 v61, v42, v43 offset0:2 offset1:3
    v_cvt_pk_bf16_f32 v44, v15, v15
    v_cvt_pk_bf16_f32 v46, v1, v14
    ds_write2_b32 v62, v44, v44 offset0:128 offset1:129
    v_cvt_pk_bf16_f32 v47, v14, v14
    v_cvt_pk_bf16_f32 v48, v17, v17
    ds_write2_b32 v62, v46, v47 offset0:130 offset1:131
    v_cvt_pk_bf16_f32 v50, v2, v16
    v_cvt_pk_bf16_f32 v51, v16, v16
    ds_write2_b32 v62, v48, v48 offset0:0 offset1:1
    v_cvt_pk_bf16_f32 v52, v4, 0
    ds_write2_b32 v62, v50, v51 offset0:2 offset1:3
    v_cndmask_b32 v52, 0, v52, s[28:29]
R_e:
    s_mov_b32 exec_hi, 0
    ds_write_b32 v63, v52 offset:4096
    s_mov_b64 exec, -1
    s_setprio 1
    s_waitcnt vmcnt(0)
    ds_write_b128 v59, v[156:159]
    ds_write_b128 v59, v[160:163] offset:1024
    ds_write_b128 v59, v[164:167] offset:2048
    s_waitcnt lgkmcnt(0)
    s_barrier
    s_branch W_conv
A_compute:
    s_mov_b32 s28, 15794176
    s_load_dword s60, s[58:59], s28
    s_mov_b32 s16, s58
    s_mov_b32 s17, s59
    s_mov_b32 s18, 0x1000000
    s_mov_b32 s19, 0x00020000
    s_mov_b32 s20, s54
    s_mov_b32 s21, s55
    s_mov_b32 s22, 0x200000
    s_mov_b32 s23, 0x00020000
    s_mov_b32 s24, s56
    s_mov_b32 s25, s57
    s_mov_b32 s26, 0x80000
    s_mov_b32 s27, 0x00020000
    v_lshlrev_b32 v224, 4, v0
    v_and_b32 v242, 31, v0
    v_lshrrev_b32 v243, 5, v0
    s_mul_i32 s28, s68, 8576
    s_lshl_b32 s29, s67, 9
    s_add_u32 s28, s28, s29
    s_add_u32 s28, s28, 141312
    v_lshlrev_b32 v1, 3, v243
    v_sub_u32 v1, v1, v242
    v_add_u32 v1, 31, v1
    v_and_b32 v2, 1, v1
    v_lshrrev_b32 v1, 1, v1
    v_lshlrev_b32 v1, 2, v1
    v_mul_u32_u24 v2, 4288, v2
    v_add3_u32 v225, v1, v2, s28
    v_add_u32 v226, 2048, v225
    s_lshl_b32 s28, s68, 4
    s_mul_i32 s29, s67, 1152
    s_add_u32 s28, s28, s29
    s_add_u32 s28, s28, 126608
    v_mul_u32_u24 v1, 144, v242
    v_lshl_add_u32 v1, v243, 5, v1
    v_add_u32 v227, s28, v1
    s_lshl_b32 s28, s67, 3
    s_sub_u32 s28, 31, s28
    s_lshl_b32 s36, -1, s28
    s_mov_b32 s37, s36
    s_bfe_u32 s38, s3, 0x10001
    s_lshl_b32 s38, s38, 16
    s_lshl_b32 s28, s35, 10
    s_add_u32 s38, s38, s28
    s_lshl_b32 s39, s63, 17
    s_add_u32 s39, s39, s38
    s_add_u32 s39, s39, 2097152
    s_lshl_b32 s28, s68, 11
    s_add_u32 s28, s28, 8192
    s_add_u32 s40, s38, s28
    s_add_u32 s41, s39, s28
    s_lshl_b32 s28, s68, 16
    v_add_u32 v232, s28, v224
    s_lshl_b32 s29, s67, 11
    s_add_u32 s29, s29, 28672
    v_add_u32 v228, s29, v232
    s_lshl_b32 s29, s67, 13
    s_add_u32 s29, s29, 28672
    v_add_u32 v229, s29, v232
    s_lshl_b32 s29, s67, 10
    v_add_u32 v230, s29, v232
    v_xor_b32 v231, 0x10000, v230
    v_mov_b32 v233, 0xdddd
    s_mov_b32 s30, 0x0000ffff
    s_mov_b32 s31, 0x0000ffff
    v_mov_b32 v1, 0x3f803f80
    v_and_b32 v2, 0x1b, v0
    v_cmp_eq_u32 vcc, 16, v2
    s_lshl_b32 s28, s64, 3
    s_lshl_b32 s29, s67, 1
    v_cndmask_b32 v234, 0, v1, vcc
    s_add_u32 s28, s28, s29
    s_lshl_b32 s45, s28, 10
    s_lshl_b32 s29, s63, 16
    s_add_u32 s45, s45, s29
    s_add_u32 s28, s28, s68
    s_lshl_b32 s43, s28, 15
    s_lshl_b32 s29, s63, 10
    s_add_u32 s43, s43, s29
    s_add_u32 s43, s43, 6291456
    v_lshlrev_b32 v1, 5, v242
    v_lshl_add_u32 v235, v243, 4, v1
    s_add_u32 s44, s69, s68
    s_lshl_b32 s44, s44, 12
    s_lshl_b32 s29, s67, 10
    s_add_u32 s44, s44, s29
    s_add_u32 s44, s44, 8388608
    v_lshrrev_b32 v1, 3, v0
    v_lshlrev_b32 v1, 10, v1
    v_and_b32 v2, 7, v0
    v_lshl_add_u32 v237, v2, 4, v1
    v_add_u32 v238, 7168, v237
    v_add_u32 v239, 14336, v237
    v_add_u32 v240, 21504, v237
    s_lshl_b32 s42, s3, 12
    s_add_u32 s42, s42, 131072
    s_lshl_b32 s47, s67, 17
    s_lshl_b32 s28, s64, 7
    s_add_u32 s47, s47, s28
    s_lshl_b32 s29, s67, 5
    s_add_u32 s28, s28, s29
    v_lshl_add_u32 v1, v2, 2, s28
    s_lshl_b32 s28, s63, 5
    v_lshl_add_u32 v241, v2, 2, s28
    v_cmp_gt_u32 vcc, 16, v0
    s_lshl_b32 s28, s67, 8
    s_and_b32 s29, s63, 28
    v_cndmask_b32 v241, v1, v241, vcc
    s_add_u32 s28, s28, s29
    v_lshl_add_u32 v1, v2, 5, s28
    v_cmp_gt_u32 vcc, 32, v0
    s_lshl_b32 s46, s63, 1
    s_add_u32 s46, s46, s68
    v_cndmask_b32 v241, v1, v241, vcc
    v_add_u32 v241, 15806464, v241
    v_lshlrev_b32 v1, 9, v243
    v_bfe_u32 v2, v0, 2, 2
    v_lshl_add_u32 v1, v2, 7, v1
    v_bfe_u32 v2, v0, 4, 1
    v_lshl_add_u32 v1, v2, 5, v1
    v_and_b32 v2, 3, v0
    v_lshl_add_u32 v1, v2, 3, v1
    v_add_u32 v236, s42, v1
    v_and_b32 v1, 15, v0
    v_lshlrev_b32 v1, 12, v1
    v_lshl_add_u32 v244, v243, 4, v1
    v_lshlrev_b32 v1, 10, v242
    v_lshl_add_u32 v245, v243, 4, v1
    v_lshrrev_b32 v1, 3, v242
    v_bfe_u32 v2, v0, 1, 1
    v_lshl_add_u32 v1, v1, 1, v2
    v_bfe_u32 v2, v0, 2, 1
    v_xor_b32 v2, v2, v243
    v_lshl_add_u32 v1, v2, 4, v1
    v_and_b32 v2, 1, v0
    v_lshlrev_b32 v2, 4, v2
    v_mov_b32 v253, 0x3f80
    v_lshlrev_b32 v2, v2, v253
    s_mov_b32 s70, 0
    s_lshl_b32 s54, s46, 7
    s_add_u32 s54, s54, 15728640
    s_lshl_b32 s55, s64, 18
    s_lshl_b32 s29, s67, 16
    s_add_u32 s55, s55, s29
    s_and_b32 s29, s46, 31
    s_lshl_b32 s29, s29, 5
    s_add_u32 s55, s55, s29
    s_lshr_b32 s29, s46, 5
    s_lshl_b32 s29, s29, 11
    s_add_u32 s55, s55, s29
    s_add_u32 s55, s55, 8388608
    s_lshl_b32 s57, s46, 15
    s_lshl_b32 s29, s67, 13
    s_add_u32 s56, s57, s29
    s_add_u32 s56, s56, 6291456
    s_lshl_b32 s29, s64, 7
    s_add_u32 s57, s57, s29
    s_lshl_b32 s29, s67, 5
    s_add_u32 s57, s57, s29
    s_lshr_b32 s28, s63, 1
    s_lshl_b32 s28, s28, 8
    s_add_u32 s28, s28, 15802368
    v_lshl_add_u32 v255, v0, 2, s28
    v_cmp_eq_u32 vcc, 0, v1
    v_cmp_eq_u32 s[28:29], 1, v1
    s_nop 0
    v_cndmask_b32 v246, 0, v2, vcc
    v_cndmask_b32 v247, 0, v2, s[28:29]
    v_cmp_eq_u32 vcc, 2, v1
    v_cmp_eq_u32 s[28:29], 3, v1
    s_nop 0
    v_cndmask_b32 v248, 0, v2, vcc
    v_cndmask_b32 v249, 0, v2, s[28:29]
    v_cmp_eq_u32 vcc, 4, v1
    v_cmp_eq_u32 s[28:29], 5, v1
    s_nop 0
    v_cndmask_b32 v250, 0, v2, vcc
    v_cndmask_b32 v251, 0, v2, s[28:29]
    v_cmp_eq_u32 vcc, 6, v1
    v_cmp_eq_u32 s[28:29], 7, v1
    s_nop 0
    v_cndmask_b32 v252, 0, v2, vcc
    v_cndmask_b32 v253, 0, v2, s[28:29]
    s_waitcnt lgkmcnt(0)
    s_mul_i32 s60, s60, 0x9E3779B1
    s_add_u32 s60, s60, 0x7F4A7C15
    v_and_b32 v3, 3, v0
    v_bfe_u32 v2, v0, 2, 2
    v_bfe_u32 v5, v0, 4, 1
    v_lshlrev_b32 v1, 5, v5
    v_lshl_add_u32 v6, v3, 3, v1
    v_lshl_add_u32 v1, v243, 9, v6
    v_lshl_add_u32 v13, v2, 6, v1
    s_lshl_b32 s28, s67, 13
    s_add_u32 s28, s28, 131072
    v_bfe_u32 v1, v0, 1, 2
    v_lshlrev_b32 v1, 4, v1
    v_lshl_add_u32 v1, v0, 6, v1
    v_add_u32 v14, s28, v1
    v_xor_b32 v15, 16, v14
    v_xor_b32 v16, 32, v14
    v_xor_b32 v17, 48, v14
    v_bfe_u32 v7, v0, 3, 1
    v_lshlrev_b32 v1, 4, v7
    v_xor_b32 v18, v13, v1
    v_add_u32 v18, s28, v18
    v_xor_b32 v19, 32, v18
    v_add_u32 v19, 256, v19
    s_lshl_b32 s29, s67, 12
    s_add_u32 s29, s29, 106496
    v_add_u32 v62, s29, v224
    v_mul_u32_u24 v1, 3072, v243
    v_lshl_add_u32 v1, v2, 7, v1
    v_xor_b32 v7, s66, v7
    v_lshl_add_u32 v1, v7, 6, v1
    v_add_u32 v1, v1, v6
    v_add_u32 v12, 32768, v1
    v_add_u32 v13, 81920, v1
    v_add_u32 v63, 139264, v1
    s_lshl_b32 s29, s35, 12
    v_bfe_u32 v2, v0, 1, 3
    v_xor_b32 v2, v2, v243
    v_lshlrev_b32 v1, 7, v242
    v_lshl_add_u32 v1, v2, 4, v1
    v_add_u32 v8, s29, v1
    v_xor_b32 v9, 32, v8
    v_xor_b32 v10, 64, v8
    v_xor_b32 v11, 96, v8
    v_add_u32 v4, 131072, v8
    v_add_u32 v5, 131072, v9
    v_add_u32 v6, 131072, v10
    v_add_u32 v7, 131072, v11
    v_and_b32 v2, 0x33, v0
    v_bfe_u32 v3, v0, 2, 1
    v_lshl_add_u32 v2, v3, 3, v2
    v_bfe_u32 v3, v0, 3, 1
    v_lshl_add_u32 v2, v3, 2, v2
    v_lshlrev_b32 v60, 4, v2
    v_and_b32 v3, 0x2f, v0
    v_lshlrev_b32 v3, 4, v3
    v_bfe_u32 v2, v0, 4, 1
    v_lshl_add_u32 v61, v2, 17, v3
    s_lshl_b32 s28, s61, 1
    s_add_u32 s28, s28, s66
    s_lshl_b32 s29, s62, 1
    s_add_u32 s29, s29, s35
    s_lshl_b32 s65, s28, 8
    s_lshl_b32 s32, s29, 2
    s_add_u32 s65, s65, s32
    s_add_u32 s65, s65, 15802368
    s_lshl_b32 s32, s28, 17
    s_lshl_b32 s33, s29, 10
    s_add_u32 s32, s32, s33
    s_add_u32 s33, s32, 65536
    s_lshl_b32 s34, s32, 1
    s_add_u32 s34, s34, 2097152
    s_add_u32 s50, s34, 131072
    s_mov_b32 s51, 0x3eb8aa3b
    s_waitcnt vmcnt(5)
    v_mul_f32 v26, 0x3fb8aa3b, v26
    v_exp_f32 v26, v26
    s_nop 0
    v_cvt_pk_bf16_f32 v26, v26, v26
    v_lshlrev_b32 v26, 16, v26
    v_mul_f32 v20, v26, v20
    v_mul_f32 v21, v26, v21
    v_mul_f32 v20, 0x3fb8aa3b, v20
    v_mul_f32 v21, 0x3e22f983, v21
    v_mul_f32 v36, 0x41000000, v20
    v_mul_f32 v37, 0x41000000, v21
    v_mul_f32 v38, 0x3f800000, v20
    v_mul_f32 v39, 0x3f800000, v21
    v_mul_f32 v40, 0x43800000, v20
    v_mul_f32 v41, 0x43800000, v21
    v_exp_f32 v36, v36
    v_fract_f32 v37, v37
    v_exp_f32 v38, v38
    v_fract_f32 v39, v39
    v_exp_f32 v40, v40
    v_fract_f32 v41, v41
    v_cos_f32 v66, v37
    v_sin_f32 v67, v37
    v_cos_f32 v44, v39
    v_sin_f32 v45, v39
    v_cos_f32 v48, v41
    v_sin_f32 v49, v41
    v_pk_mul_f32 v[66:67], v[66:67], v[36:37] op_sel:[0,0] op_sel_hi:[1,0]
    v_pk_mul_f32 v[44:45], v[44:45], v[38:39] op_sel:[0,0] op_sel_hi:[1,0]
    v_pk_mul_f32 v[48:49], v[48:49], v[40:41] op_sel:[0,0] op_sel_hi:[1,0]
    v_mov_b32 v64, 1.0
    v_mov_b32 v65, 0
    s_waitcnt vmcnt(0)
    v_pk_mul_f32 v[68:69], v[66:67], v[66:67] op_sel:[0,0] op_sel_hi:[0,1]
    v_pk_mul_f32 v[160:161], v[22:23], v[24:25] op_sel:[0,0] op_sel_hi:[0,1]
    v_pk_mul_f32 v[178:179], v[44:45], v[44:45] op_sel:[0,0] op_sel_hi:[0,1]
    v_pk_mul_f32 v[182:183], v[48:49], v[48:49] op_sel:[0,0] op_sel_hi:[0,1]
    v_pk_fma_f32 v[68:69], v[66:67], v[66:67], v[68:69] op_sel:[1,1,0] op_sel_hi:[1,0,1] neg_lo:[1,0,0]
    v_pk_fma_f32 v[160:161], v[22:23], v[24:25], v[160:161] op_sel:[1,1,0] op_sel_hi:[1,0,1] neg_lo:[1,0,0]
    v_pk_fma_f32 v[178:179], v[44:45], v[44:45], v[178:179] op_sel:[1,1,0] op_sel_hi:[1,0,1] neg_lo:[1,0,0]
    v_pk_fma_f32 v[182:183], v[48:49], v[48:49], v[182:183] op_sel:[1,1,0] op_sel_hi:[1,0,1] neg_lo:[1,0,0]
    v_pk_mul_f32 v[160:161], v[160:161], v[26:27] op_sel:[0,0] op_sel_hi:[1,0]
    v_pk_mul_f32 v[70:71], v[66:67], v[68:69] op_sel:[0,0] op_sel_hi:[0,1]
    v_pk_mul_f32 v[72:73], v[68:69], v[68:69] op_sel:[0,0] op_sel_hi:[0,1]
    v_pk_mul_f32 v[180:181], v[178:179], v[178:179] op_sel:[0,0] op_sel_hi:[0,1]
    v_pk_mul_f32 v[184:185], v[182:183], v[48:49] op_sel:[0,0] op_sel_hi:[0,1]
    v_pk_mul_f32 v[186:187], v[182:183], v[182:183] op_sel:[0,0] op_sel_hi:[0,1]
    v_pk_mul_f32 v[162:163], v[160:161], v[44:45] op_sel:[0,0] op_sel_hi:[0,1]
    v_pk_mul_f32 v[176:177], v[160:161], v[66:67] op_sel:[0,0] op_sel_hi:[0,1]
    v_pk_mul_f32 v[164:165], v[160:161], v[178:179] op_sel:[0,0] op_sel_hi:[0,1]
    v_pk_fma_f32 v[70:71], v[66:67], v[68:69], v[70:71] op_sel:[1,1,0] op_sel_hi:[1,0,1] neg_lo:[1,0,0]
    v_pk_fma_f32 v[72:73], v[68:69], v[68:69], v[72:73] op_sel:[1,1,0] op_sel_hi:[1,0,1] neg_lo:[1,0,0]
    v_pk_fma_f32 v[180:181], v[178:179], v[178:179], v[180:181] op_sel:[1,1,0] op_sel_hi:[1,0,1] neg_lo:[1,0,0]
    v_pk_fma_f32 v[184:185], v[182:183], v[48:49], v[184:185] op_sel:[1,1,0] op_sel_hi:[1,0,1] neg_lo:[1,0,0]
    v_pk_fma_f32 v[186:187], v[182:183], v[182:183], v[186:187] op_sel:[1,1,0] op_sel_hi:[1,0,1] neg_lo:[1,0,0]
    v_pk_fma_f32 v[162:163], v[160:161], v[44:45], v[162:163] op_sel:[1,1,0] op_sel_hi:[1,0,1] neg_lo:[1,0,0]
    v_pk_fma_f32 v[176:177], v[160:161], v[66:67], v[176:177] op_sel:[1,1,0] op_sel_hi:[1,0,1] neg_lo:[1,0,0]
    v_pk_fma_f32 v[164:165], v[160:161], v[178:179], v[164:165] op_sel:[1,1,0] op_sel_hi:[1,0,1] neg_lo:[1,0,0]
    v_pk_mul_f32 v[74:75], v[66:67], v[72:73] op_sel:[0,0] op_sel_hi:[0,1]
    v_pk_mul_f32 v[76:77], v[68:69], v[72:73] op_sel:[0,0] op_sel_hi:[0,1]
    v_pk_mul_f32 v[78:79], v[70:71], v[72:73] op_sel:[0,0] op_sel_hi:[0,1]
    v_pk_mul_f32 v[80:81], v[72:73], v[72:73] op_sel:[0,0] op_sel_hi:[0,1]
    v_pk_mul_f32 v[166:167], v[162:163], v[178:179] op_sel:[0,0] op_sel_hi:[0,1]
    v_pk_mul_f32 v[188:189], v[186:187], v[48:49] op_sel:[0,0] op_sel_hi:[0,1]
    v_pk_mul_f32 v[190:191], v[186:187], v[182:183] op_sel:[0,0] op_sel_hi:[0,1]
    v_pk_mul_f32 v[192:193], v[186:187], v[184:185] op_sel:[0,0] op_sel_hi:[0,1]
    v_pk_fma_f32 v[74:75], v[66:67], v[72:73], v[74:75] op_sel:[1,1,0] op_sel_hi:[1,0,1] neg_lo:[1,0,0]
    v_pk_fma_f32 v[76:77], v[68:69], v[72:73], v[76:77] op_sel:[1,1,0] op_sel_hi:[1,0,1] neg_lo:[1,0,0]
    v_pk_fma_f32 v[78:79], v[70:71], v[72:73], v[78:79] op_sel:[1,1,0] op_sel_hi:[1,0,1] neg_lo:[1,0,0]
    v_pk_fma_f32 v[80:81], v[72:73], v[72:73], v[80:81] op_sel:[1,1,0] op_sel_hi:[1,0,1] neg_lo:[1,0,0]
    v_pk_fma_f32 v[166:167], v[162:163], v[178:179], v[166:167] op_sel:[1,1,0] op_sel_hi:[1,0,1] neg_lo:[1,0,0]
    v_pk_fma_f32 v[188:189], v[186:187], v[48:49], v[188:189] op_sel:[1,1,0] op_sel_hi:[1,0,1] neg_lo:[1,0,0]
    v_pk_fma_f32 v[190:191], v[186:187], v[182:183], v[190:191] op_sel:[1,1,0] op_sel_hi:[1,0,1] neg_lo:[1,0,0]
    v_pk_fma_f32 v[192:193], v[186:187], v[184:185], v[192:193] op_sel:[1,1,0] op_sel_hi:[1,0,1] neg_lo:[1,0,0]
    v_cvt_pk_bf16_f32 v28, v64, v66
    v_cvt_pk_bf16_f32 v29, v68, v70
    v_cvt_pk_bf16_f32 v30, v72, v74
    v_cvt_pk_bf16_f32 v31, v76, v78
    ds_write_b128 v14, v[28:31]
    v_cvt_pk_bf16_f32 v32, -v65, -v67
    v_cvt_pk_bf16_f32 v33, -v69, -v71
    v_cvt_pk_bf16_f32 v34, -v73, -v75
    v_cvt_pk_bf16_f32 v35, -v77, -v79
    ds_write_b128 v14, v[32:35] offset:4096
    v_pk_mul_f32 v[82:83], v[66:67], v[80:81] op_sel:[0,0] op_sel_hi:[0,1]
    v_pk_mul_f32 v[84:85], v[68:69], v[80:81] op_sel:[0,0] op_sel_hi:[0,1]
    v_pk_mul_f32 v[86:87], v[70:71], v[80:81] op_sel:[0,0] op_sel_hi:[0,1]
    v_pk_mul_f32 v[88:89], v[72:73], v[80:81] op_sel:[0,0] op_sel_hi:[0,1]
    v_pk_mul_f32 v[90:91], v[74:75], v[80:81] op_sel:[0,0] op_sel_hi:[0,1]
    v_pk_mul_f32 v[92:93], v[76:77], v[80:81] op_sel:[0,0] op_sel_hi:[0,1]
    v_pk_mul_f32 v[94:95], v[78:79], v[80:81] op_sel:[0,0] op_sel_hi:[0,1]
    v_pk_mul_f32 v[96:97], v[80:81], v[80:81] op_sel:[0,0] op_sel_hi:[0,1]
    v_pk_fma_f32 v[82:83], v[66:67], v[80:81], v[82:83] op_sel:[1,1,0] op_sel_hi:[1,0,1] neg_lo:[1,0,0]
    v_pk_fma_f32 v[84:85], v[68:69], v[80:81], v[84:85] op_sel:[1,1,0] op_sel_hi:[1,0,1] neg_lo:[1,0,0]
    v_pk_fma_f32 v[86:87], v[70:71], v[80:81], v[86:87] op_sel:[1,1,0] op_sel_hi:[1,0,1] neg_lo:[1,0,0]
    v_pk_fma_f32 v[88:89], v[72:73], v[80:81], v[88:89] op_sel:[1,1,0] op_sel_hi:[1,0,1] neg_lo:[1,0,0]
    v_pk_fma_f32 v[90:91], v[74:75], v[80:81], v[90:91] op_sel:[1,1,0] op_sel_hi:[1,0,1] neg_lo:[1,0,0]
    v_pk_fma_f32 v[92:93], v[76:77], v[80:81], v[92:93] op_sel:[1,1,0] op_sel_hi:[1,0,1] neg_lo:[1,0,0]
    v_pk_fma_f32 v[94:95], v[78:79], v[80:81], v[94:95] op_sel:[1,1,0] op_sel_hi:[1,0,1] neg_lo:[1,0,0]
    v_pk_fma_f32 v[96:97], v[80:81], v[80:81], v[96:97] op_sel:[1,1,0] op_sel_hi:[1,0,1] neg_lo:[1,0,0]
    v_cvt_pk_bf16_f32 v52, v80, v82
    v_cvt_pk_bf16_f32 v53, v84, v86
    v_cvt_pk_bf16_f32 v54, v88, v90
    v_cvt_pk_bf16_f32 v55, v92, v94
    ds_write_b128 v15, v[52:55]
    v_cvt_pk_bf16_f32 v56, -v81, -v83
    v_cvt_pk_bf16_f32 v57, -v85, -v87
    v_cvt_pk_bf16_f32 v58, -v89, -v91
    v_cvt_pk_bf16_f32 v59, -v93, -v95
    ds_write_b128 v15, v[56:59] offset:4096
    v_pk_mul_f32 v[98:99], v[66:67], v[96:97] op_sel:[0,0] op_sel_hi:[0,1]
    v_pk_mul_f32 v[100:101], v[68:69], v[96:97] op_sel:[0,0] op_sel_hi:[0,1]
    v_pk_mul_f32 v[102:103], v[70:71], v[96:97] op_sel:[0,0] op_sel_hi:[0,1]
    v_pk_mul_f32 v[104:105], v[72:73], v[96:97] op_sel:[0,0] op_sel_hi:[0,1]
    v_pk_mul_f32 v[106:107], v[74:75], v[96:97] op_sel:[0,0] op_sel_hi:[0,1]
    v_pk_mul_f32 v[108:109], v[76:77], v[96:97] op_sel:[0,0] op_sel_hi:[0,1]
    v_pk_mul_f32 v[110:111], v[78:79], v[96:97] op_sel:[0,0] op_sel_hi:[0,1]
    v_pk_fma_f32 v[98:99], v[66:67], v[96:97], v[98:99] op_sel:[1,1,0] op_sel_hi:[1,0,1] neg_lo:[1,0,0]
    v_pk_fma_f32 v[100:101], v[68:69], v[96:97], v[100:101] op_sel:[1,1,0] op_sel_hi:[1,0,1] neg_lo:[1,0,0]
    v_pk_fma_f32 v[102:103], v[70:71], v[96:97], v[102:103] op_sel:[1,1,0] op_sel_hi:[1,0,1] neg_lo:[1,0,0]
    v_pk_fma_f32 v[104:105], v[72:73], v[96:97], v[104:105] op_sel:[1,1,0] op_sel_hi:[1,0,1] neg_lo:[1,0,0]
    v_pk_fma_f32 v[106:107], v[74:75], v[96:97], v[106:107] op_sel:[1,1,0] op_sel_hi:[1,0,1] neg_lo:[1,0,0]
    v_pk_fma_f32 v[108:109], v[76:77], v[96:97], v[108:109] op_sel:[1,1,0] op_sel_hi:[1,0,1] neg_lo:[1,0,0]
    v_pk_fma_f32 v[110:111], v[78:79], v[96:97], v[110:111] op_sel:[1,1,0] op_sel_hi:[1,0,1] neg_lo:[1,0,0]
    v_cvt_pk_bf16_f32 v28, v96, v98
    v_cvt_pk_bf16_f32 v29, v100, v102
    v_cvt_pk_bf16_f32 v30, v104, v106
    v_cvt_pk_bf16_f32 v31, v108, v110
    ds_write_b128 v16, v[28:31]
    v_cvt_pk_bf16_f32 v32, -v97, -v99
    v_cvt_pk_bf16_f32 v33, -v101, -v103
    v_cvt_pk_bf16_f32 v34, -v105, -v107
    v_cvt_pk_bf16_f32 v35, -v109, -v111
    ds_write_b128 v16, v[32:35] offset:4096
    v_pk_mul_f32 v[112:113], v[80:81], v[96:97] op_sel:[0,0] op_sel_hi:[0,1]
    v_pk_mul_f32 v[114:115], v[82:83], v[96:97] op_sel:[0,0] op_sel_hi:[0,1]
    v_pk_mul_f32 v[116:117], v[84:85], v[96:97] op_sel:[0,0] op_sel_hi:[0,1]
    v_pk_mul_f32 v[118:119], v[86:87], v[96:97] op_sel:[0,0] op_sel_hi:[0,1]
    v_pk_mul_f32 v[120:121], v[88:89], v[96:97] op_sel:[0,0] op_sel_hi:[0,1]
    v_pk_mul_f32 v[122:123], v[90:91], v[96:97] op_sel:[0,0] op_sel_hi:[0,1]
    v_pk_mul_f32 v[124:125], v[92:93], v[96:97] op_sel:[0,0] op_sel_hi:[0,1]
    v_pk_mul_f32 v[126:127], v[94:95], v[96:97] op_sel:[0,0] op_sel_hi:[0,1]
    v_pk_fma_f32 v[112:113], v[80:81], v[96:97], v[112:113] op_sel:[1,1,0] op_sel_hi:[1,0,1] neg_lo:[1,0,0]
    v_pk_fma_f32 v[114:115], v[82:83], v[96:97], v[114:115] op_sel:[1,1,0] op_sel_hi:[1,0,1] neg_lo:[1,0,0]
    v_pk_fma_f32 v[116:117], v[84:85], v[96:97], v[116:117] op_sel:[1,1,0] op_sel_hi:[1,0,1] neg_lo:[1,0,0]
    v_pk_fma_f32 v[118:119], v[86:87], v[96:97], v[118:119] op_sel:[1,1,0] op_sel_hi:[1,0,1] neg_lo:[1,0,0]
    v_pk_fma_f32 v[120:121], v[88:89], v[96:97], v[120:121] op_sel:[1,1,0] op_sel_hi:[1,0,1] neg_lo:[1,0,0]
    v_pk_fma_f32 v[122:123], v[90:91], v[96:97], v[122:123] op_sel:[1,1,0] op_sel_hi:[1,0,1] neg_lo:[1,0,0]
    v_pk_fma_f32 v[124:125], v[92:93], v[96:97], v[124:125] op_sel:[1,1,0] op_sel_hi:[1,0,1] neg_lo:[1,0,0]
    v_pk_fma_f32 v[126:127], v[94:95], v[96:97], v[126:127] op_sel:[1,1,0] op_sel_hi:[1,0,1] neg_lo:[1,0,0]
    v_cvt_pk_bf16_f32 v52, v112, v114
    v_cvt_pk_bf16_f32 v53, v116, v118
    v_cvt_pk_bf16_f32 v54, v120, v122
    v_cvt_pk_bf16_f32 v55, v124, v126
    ds_write_b128 v17, v[52:55]
    v_cvt_pk_bf16_f32 v56, -v113, -v115
    v_cvt_pk_bf16_f32 v57, -v117, -v119
    v_cvt_pk_bf16_f32 v58, -v121, -v123
    v_cvt_pk_bf16_f32 v59, -v125, -v127
    ds_write_b128 v17, v[56:59] offset:4096
    ds_read_b64_tr_b16 v[128:129], v18 offset:0
    ds_read_b64_tr_b16 v[130:131], v19 offset:0
    ds_read_b64_tr_b16 v[132:133], v18 offset:1024
    ds_read_b64_tr_b16 v[134:135], v19 offset:1024
    ds_read_b64_tr_b16 v[136:137], v18 offset:2048
    ds_read_b64_tr_b16 v[138:139], v19 offset:2048
    ds_read_b64_tr_b16 v[140:141], v18 offset:3072
    ds_read_b64_tr_b16 v[142:143], v19 offset:3072
    ds_read_b64_tr_b16 v[144:145], v18 offset:4096
    ds_read_b64_tr_b16 v[146:147], v19 offset:4096
    ds_read_b64_tr_b16 v[148:149], v18 offset:5120
    ds_read_b64_tr_b16 v[150:151], v19 offset:5120
    ds_read_b64_tr_b16 v[152:153], v18 offset:6144
    ds_read_b64_tr_b16 v[154:155], v19 offset:6144
    ds_read_b64_tr_b16 v[156:157], v18 offset:7168
    ds_read_b64_tr_b16 v[158:159], v19 offset:7168
    v_pk_mul_f32 v[168:169], v[160:161], v[180:181] op_sel:[0,0] op_sel_hi:[0,1]
    v_pk_mul_f32 v[170:171], v[162:163], v[180:181] op_sel:[0,0] op_sel_hi:[0,1]
    v_pk_mul_f32 v[172:173], v[164:165], v[180:181] op_sel:[0,0] op_sel_hi:[0,1]
    v_pk_mul_f32 v[174:175], v[166:167], v[180:181] op_sel:[0,0] op_sel_hi:[0,1]
    v_pk_fma_f32 v[168:169], v[160:161], v[180:181], v[168:169] op_sel:[1,1,0] op_sel_hi:[1,0,1] neg_lo:[1,0,0]
    v_pk_fma_f32 v[170:171], v[162:163], v[180:181], v[170:171] op_sel:[1,1,0] op_sel_hi:[1,0,1] neg_lo:[1,0,0]
    v_pk_fma_f32 v[172:173], v[164:165], v[180:181], v[172:173] op_sel:[1,1,0] op_sel_hi:[1,0,1] neg_lo:[1,0,0]
    v_pk_fma_f32 v[174:175], v[166:167], v[180:181], v[174:175] op_sel:[1,1,0] op_sel_hi:[1,0,1] neg_lo:[1,0,0]
    v_cvt_pk_bf16_f32 v28, v160, v162
    v_cvt_pk_bf16_f32 v29, v164, v166
    v_cvt_pk_bf16_f32 v30, v168, v170
    v_cvt_pk_bf16_f32 v31, v172, v174
    ds_write_b128 v14, v[28:31]
    v_cvt_pk_bf16_f32 v32, v161, v163
    v_cvt_pk_bf16_f32 v33, v165, v167
    v_cvt_pk_bf16_f32 v34, v169, v171
    v_cvt_pk_bf16_f32 v35, v173, v175
    ds_write_b128 v14, v[32:35] offset:4096
    v_pk_mul_f32 v[64:65], v[160:161], v[48:49] op_sel:[0,0] op_sel_hi:[0,1]
    v_pk_mul_f32 v[66:67], v[164:165], v[48:49] op_sel:[0,0] op_sel_hi:[0,1]
    v_pk_mul_f32 v[68:69], v[168:169], v[48:49] op_sel:[0,0] op_sel_hi:[0,1]
    v_pk_mul_f32 v[70:71], v[160:161], v[182:183] op_sel:[0,0] op_sel_hi:[0,1]
    v_pk_mul_f32 v[72:73], v[172:173], v[48:49] op_sel:[0,0] op_sel_hi:[0,1]
    v_pk_mul_f32 v[74:75], v[176:177], v[48:49] op_sel:[0,0] op_sel_hi:[0,1]
    v_pk_mul_f32 v[76:77], v[160:161], v[184:185] op_sel:[0,0] op_sel_hi:[0,1]
    v_pk_fma_f32 v[64:65], v[160:161], v[48:49], v[64:65] op_sel:[1,1,0] op_sel_hi:[1,0,1] neg_lo:[1,0,0]
    v_pk_fma_f32 v[66:67], v[164:165], v[48:49], v[66:67] op_sel:[1,1,0] op_sel_hi:[1,0,1] neg_lo:[1,0,0]
    v_pk_fma_f32 v[68:69], v[168:169], v[48:49], v[68:69] op_sel:[1,1,0] op_sel_hi:[1,0,1] neg_lo:[1,0,0]
    v_pk_fma_f32 v[70:71], v[160:161], v[182:183], v[70:71] op_sel:[1,1,0] op_sel_hi:[1,0,1] neg_lo:[1,0,0]
    v_pk_fma_f32 v[72:73], v[172:173], v[48:49], v[72:73] op_sel:[1,1,0] op_sel_hi:[1,0,1] neg_lo:[1,0,0]
    v_pk_fma_f32 v[74:75], v[176:177], v[48:49], v[74:75] op_sel:[1,1,0] op_sel_hi:[1,0,1] neg_lo:[1,0,0]
    v_pk_fma_f32 v[76:77], v[160:161], v[184:185], v[76:77] op_sel:[1,1,0] op_sel_hi:[1,0,1] neg_lo:[1,0,0]
    v_cvt_pk_bf16_f32 v52, v64, v66
    v_cvt_pk_bf16_f32 v53, v68, v70
    v_cvt_pk_bf16_f32 v54, v68, v72
    v_cvt_pk_bf16_f32 v55, v74, v76
    ds_write_b128 v15, v[52:55]
    v_cvt_pk_bf16_f32 v56, v65, v67
    v_cvt_pk_bf16_f32 v57, v69, v71
    v_cvt_pk_bf16_f32 v58, v69, v73
    v_cvt_pk_bf16_f32 v59, v75, v77
    ds_write_b128 v15, v[56:59] offset:4096
    v_pk_mul_f32 v[78:79], v[168:169], v[182:183] op_sel:[0,0] op_sel_hi:[0,1]
    v_pk_mul_f32 v[80:81], v[176:177], v[182:183] op_sel:[0,0] op_sel_hi:[0,1]
    v_pk_mul_f32 v[82:83], v[160:161], v[186:187] op_sel:[0,0] op_sel_hi:[0,1]
    v_pk_mul_f32 v[84:85], v[176:177], v[186:187] op_sel:[0,0] op_sel_hi:[0,1]
    v_pk_mul_f32 v[86:87], v[168:169], v[184:185] op_sel:[0,0] op_sel_hi:[0,1]
    v_pk_mul_f32 v[88:89], v[176:177], v[184:185] op_sel:[0,0] op_sel_hi:[0,1]
    v_pk_mul_f32 v[90:91], v[160:161], v[190:191] op_sel:[0,0] op_sel_hi:[0,1]
    v_pk_mul_f32 v[92:93], v[176:177], v[190:191] op_sel:[0,0] op_sel_hi:[0,1]
    v_pk_fma_f32 v[78:79], v[168:169], v[182:183], v[78:79] op_sel:[1,1,0] op_sel_hi:[1,0,1] neg_lo:[1,0,0]
    v_pk_fma_f32 v[80:81], v[176:177], v[182:183], v[80:81] op_sel:[1,1,0] op_sel_hi:[1,0,1] neg_lo:[1,0,0]
    v_pk_fma_f32 v[82:83], v[160:161], v[186:187], v[82:83] op_sel:[1,1,0] op_sel_hi:[1,0,1] neg_lo:[1,0,0]
    v_pk_fma_f32 v[84:85], v[176:177], v[186:187], v[84:85] op_sel:[1,1,0] op_sel_hi:[1,0,1] neg_lo:[1,0,0]
    v_pk_fma_f32 v[86:87], v[168:169], v[184:185], v[86:87] op_sel:[1,1,0] op_sel_hi:[1,0,1] neg_lo:[1,0,0]
    v_pk_fma_f32 v[88:89], v[176:177], v[184:185], v[88:89] op_sel:[1,1,0] op_sel_hi:[1,0,1] neg_lo:[1,0,0]
    v_pk_fma_f32 v[90:91], v[160:161], v[190:191], v[90:91] op_sel:[1,1,0] op_sel_hi:[1,0,1] neg_lo:[1,0,0]
    v_pk_fma_f32 v[92:93], v[176:177], v[190:191], v[92:93] op_sel:[1,1,0] op_sel_hi:[1,0,1] neg_lo:[1,0,0]
    v_cvt_pk_bf16_f32 v28, v78, v80
    v_cvt_pk_bf16_f32 v29, v82, v84
    v_cvt_pk_bf16_f32 v30, v86, v88
    v_cvt_pk_bf16_f32 v31, v90, v92
    ds_write_b128 v16, v[28:31]
    v_cvt_pk_bf16_f32 v32, v79, v81
    v_cvt_pk_bf16_f32 v33, v83, v85
    v_cvt_pk_bf16_f32 v34, v87, v89
    v_cvt_pk_bf16_f32 v35, v91, v93
    ds_write_b128 v16, v[32:35] offset:4096
    v_pk_mul_f32 v[94:95], v[160:161], v[188:189] op_sel:[0,0] op_sel_hi:[0,1]
    v_pk_mul_f32 v[96:97], v[176:177], v[188:189] op_sel:[0,0] op_sel_hi:[0,1]
    v_pk_mul_f32 v[98:99], v[160:161], v[192:193] op_sel:[0,0] op_sel_hi:[0,1]
    v_pk_mul_f32 v[100:101], v[176:177], v[192:193] op_sel:[0,0] op_sel_hi:[0,1]
    v_pk_fma_f32 v[94:95], v[160:161], v[188:189], v[94:95] op_sel:[1,1,0] op_sel_hi:[1,0,1] neg_lo:[1,0,0]
    v_pk_fma_f32 v[96:97], v[176:177], v[188:189], v[96:97] op_sel:[1,1,0] op_sel_hi:[1,0,1] neg_lo:[1,0,0]
    v_pk_fma_f32 v[98:99], v[160:161], v[192:193], v[98:99] op_sel:[1,1,0] op_sel_hi:[1,0,1] neg_lo:[1,0,0]
    v_pk_fma_f32 v[100:101], v[176:177], v[192:193], v[100:101] op_sel:[1,1,0] op_sel_hi:[1,0,1] neg_lo:[1,0,0]
    v_cvt_pk_bf16_f32 v52, v94, v96
    v_cvt_pk_bf16_f32 v53, v168, v160
    v_cvt_pk_bf16_f32 v54, v98, v100
    v_cvt_pk_bf16_f32 v55, v176, v160
    ds_write_b128 v17, v[52:55]
    v_cvt_pk_bf16_f32 v56, v95, v97
    v_cvt_pk_bf16_f32 v57, v169, v161
    v_cvt_pk_bf16_f32 v58, v99, v101
    v_cvt_pk_bf16_f32 v59, v177, v161
    ds_write_b128 v17, v[56:59] offset:4096
    ds_read_b64_tr_b16 v[192:193], v18 offset:0
    ds_read_b64_tr_b16 v[194:195], v19 offset:0
    ds_read_b64_tr_b16 v[196:197], v18 offset:1024
    ds_read_b64_tr_b16 v[198:199], v19 offset:1024
    ds_read_b64_tr_b16 v[200:201], v18 offset:2048
    ds_read_b64_tr_b16 v[202:203], v19 offset:2048
    ds_read_b64_tr_b16 v[204:205], v18 offset:3072
    ds_read_b64_tr_b16 v[206:207], v19 offset:3072
    ds_read_b64_tr_b16 v[208:209], v18 offset:4096
    ds_read_b64_tr_b16 v[210:211], v19 offset:4096
    ds_read_b64_tr_b16 v[212:213], v18 offset:5120
    ds_read_b64_tr_b16 v[214:215], v19 offset:5120
    ds_read_b64_tr_b16 v[216:217], v18 offset:6144
    ds_read_b64_tr_b16 v[218:219], v19 offset:6144
    ds_read_b64_tr_b16 v[220:221], v18 offset:7168
    ds_read_b64_tr_b16 v[222:223], v19 offset:7168
    s_barrier
    ds_read_b128 v[28:31], v8 offset:0
    ds_read_b64_tr_b16 v[36:37], v12 offset:1024
    ds_read_b64_tr_b16 v[38:39], v12 offset:1536
    ds_read_b64_tr_b16 v[40:41], v12 offset:2048
    ds_read_b64_tr_b16 v[42:43], v12 offset:2560
    ds_read_b64_tr_b16 v[32:33], v12 offset:0
    ds_read_b64_tr_b16 v[34:35], v12 offset:512
    ds_read_b128 v[44:47], v9 offset:0
    ds_read_b64_tr_b16 v[52:53], v12 offset:7168
    ds_read_b64_tr_b16 v[54:55], v12 offset:7680
    ds_read_b64_tr_b16 v[56:57], v12 offset:8192
    ds_read_b64_tr_b16 v[58:59], v12 offset:8704
    ds_read_b64_tr_b16 v[48:49], v12 offset:6144
    ds_read_b64_tr_b16 v[50:51], v12 offset:6656
    ds_read_b128 v[112:115], v10 offset:0
    ds_read_b64_tr_b16 v[120:121], v12 offset:13312
    ds_read_b64_tr_b16 v[122:123], v12 offset:13824
    ds_read_b64_tr_b16 v[124:125], v12 offset:14336
    ds_read_b64_tr_b16 v[126:127], v12 offset:14848
    ds_read_b64_tr_b16 v[116:117], v12 offset:12288
    ds_read_b64_tr_b16 v[118:119], v12 offset:12800
    s_waitcnt lgkmcnt(14)
    v_mfma_f32_32x32x16_bf16 v[80:95], v[36:39], v[28:31], 0
    ds_read_b128 v[160:163], v11 offset:0
    ds_read_b64_tr_b16 v[168:169], v12 offset:19456
    ds_read_b64_tr_b16 v[170:171], v12 offset:19968
    v_mfma_f32_32x32x16_bf16 v[96:111], v[28:31], v[40:43], 0
    ds_read_b64_tr_b16 v[172:173], v12 offset:20480
    ds_read_b64_tr_b16 v[174:175], v12 offset:20992
    ds_read_b64_tr_b16 v[164:165], v12 offset:18432
    v_mfma_f32_32x32x16_bf16 v[64:79], v[32:35], v[28:31], 0
    ds_read_b64_tr_b16 v[166:167], v12 offset:18944
    s_waitcnt lgkmcnt(14)
    v_mfma_f32_32x32x16_bf16 v[80:95], v[52:55], v[44:47], v[80:95]
    v_mfma_f32_32x32x16_bf16 v[96:111], v[44:47], v[56:59], v[96:111]
    v_mfma_f32_32x32x16_bf16 v[64:79], v[48:51], v[44:47], v[64:79]
    s_waitcnt lgkmcnt(0)
    s_barrier
    v_mfma_f32_32x32x16_bf16 v[80:95], v[120:123], v[112:115], v[80:95]
    ds_read_b128 v[28:31], v8 offset:8192
    ds_read_b64_tr_b16 v[36:37], v12 offset:25600
    ds_read_b64_tr_b16 v[38:39], v12 offset:26112
    ds_read_b64_tr_b16 v[40:41], v12 offset:26624
    ds_read_b64_tr_b16 v[42:43], v12 offset:27136
    v_mfma_f32_32x32x16_bf16 v[96:111], v[112:115], v[124:127], v[96:111]
    ds_read_b64_tr_b16 v[32:33], v12 offset:24576
    ds_read_b64_tr_b16 v[34:35], v12 offset:25088
    ds_read_b128 v[44:47], v9 offset:8192
    ds_read_b64_tr_b16 v[52:53], v12 offset:31744
    ds_read_b64_tr_b16 v[54:55], v12 offset:32256
    v_mfma_f32_32x32x16_bf16 v[64:79], v[116:119], v[112:115], v[64:79]
    ds_read_b64_tr_b16 v[56:57], v12 offset:32768
    ds_read_b64_tr_b16 v[58:59], v12 offset:33280
    ds_read_b64_tr_b16 v[48:49], v12 offset:30720
    ds_read_b64_tr_b16 v[50:51], v12 offset:31232
    v_mfma_f32_32x32x16_bf16 v[80:95], v[168:171], v[160:163], v[80:95]
    ds_read_b128 v[112:115], v10 offset:8192
    ds_read_b64_tr_b16 v[120:121], v12 offset:37888
    ds_read_b64_tr_b16 v[122:123], v12 offset:38400
    v_mfma_f32_32x32x16_bf16 v[96:111], v[160:163], v[172:175], v[96:111]
    ds_read_b64_tr_b16 v[124:125], v12 offset:38912
    ds_read_b64_tr_b16 v[126:127], v12 offset:39424
    ds_read_b64_tr_b16 v[116:117], v12 offset:36864
    v_mfma_f32_32x32x16_bf16 v[64:79], v[164:167], v[160:163], v[64:79]
    ds_read_b64_tr_b16 v[118:119], v12 offset:37376
    s_waitcnt lgkmcnt(14)
    v_mfma_f32_32x32x16_bf16 v[80:95], v[36:39], v[28:31], v[80:95]
    ds_read_b128 v[160:163], v11 offset:8192
    ds_read_b64_tr_b16 v[168:169], v12 offset:44032
    ds_read_b64_tr_b16 v[170:171], v12 offset:44544
    v_mfma_f32_32x32x16_bf16 v[96:111], v[28:31], v[40:43], v[96:111]
    ds_read_b64_tr_b16 v[172:173], v12 offset:45056
    ds_read_b64_tr_b16 v[174:175], v12 offset:45568
    ds_read_b64_tr_b16 v[164:165], v12 offset:43008
    v_mfma_f32_32x32x16_bf16 v[64:79], v[32:35], v[28:31], v[64:79]
    ds_read_b64_tr_b16 v[166:167], v12 offset:43520
    s_waitcnt lgkmcnt(14)
    v_mfma_f32_32x32x16_bf16 v[80:95], v[52:55], v[44:47], v[80:95]
    v_mfma_f32_32x32x16_bf16 v[96:111], v[44:47], v[56:59], v[96:111]
    v_mfma_f32_32x32x16_bf16 v[64:79], v[48:51], v[44:47], v[64:79]
    s_waitcnt lgkmcnt(0)
    s_barrier
    v_mfma_f32_32x32x16_bf16 v[80:95], v[120:123], v[112:115], v[80:95]
    ds_read_b128 v[28:31], v8 offset:16384
    ds_read_b64_tr_b16 v[36:37], v13 offset:1024
    ds_read_b64_tr_b16 v[38:39], v13 offset:1536
    ds_read_b64_tr_b16 v[40:41], v13 offset:2048
    ds_read_b64_tr_b16 v[42:43], v13 offset:2560
    v_mfma_f32_32x32x16_bf16 v[96:111], v[112:115], v[124:127], v[96:111]
    ds_read_b64_tr_b16 v[32:33], v13 offset:0
    ds_read_b64_tr_b16 v[34:35], v13 offset:512
    ds_read_b128 v[44:47], v9 offset:16384
    ds_read_b64_tr_b16 v[52:53], v13 offset:7168
    ds_read_b64_tr_b16 v[54:55], v13 offset:7680
    v_mfma_f32_32x32x16_bf16 v[64:79], v[116:119], v[112:115], v[64:79]
    ds_read_b64_tr_b16 v[56:57], v13 offset:8192
    ds_read_b64_tr_b16 v[58:59], v13 offset:8704
    ds_read_b64_tr_b16 v[48:49], v13 offset:6144
    ds_read_b64_tr_b16 v[50:51], v13 offset:6656
    v_mfma_f32_32x32x16_bf16 v[80:95], v[168:171], v[160:163], v[80:95]
    ds_read_b128 v[112:115], v10 offset:16384
    ds_read_b64_tr_b16 v[120:121], v13 offset:13312
    ds_read_b64_tr_b16 v[122:123], v13 offset:13824
    v_mfma_f32_32x32x16_bf16 v[96:111], v[160:163], v[172:175], v[96:111]
    ds_read_b64_tr_b16 v[124:125], v13 offset:14336
    ds_read_b64_tr_b16 v[126:127], v13 offset:14848
    ds_read_b64_tr_b16 v[116:117], v13 offset:12288
    v_mfma_f32_32x32x16_bf16 v[64:79], v[164:167], v[160:163], v[64:79]
    ds_read_b64_tr_b16 v[118:119], v13 offset:12800
    s_waitcnt lgkmcnt(14)
    v_mfma_f32_32x32x16_bf16 v[80:95], v[36:39], v[28:31], v[80:95]
    ds_read_b128 v[160:163], v11 offset:16384
    ds_read_b64_tr_b16 v[168:169], v13 offset:19456
    ds_read_b64_tr_b16 v[170:171], v13 offset:19968
    v_mfma_f32_32x32x16_bf16 v[96:111], v[28:31], v[40:43], v[96:111]
    ds_read_b64_tr_b16 v[172:173], v13 offset:20480
    ds_read_b64_tr_b16 v[174:175], v13 offset:20992
    ds_read_b64_tr_b16 v[164:165], v13 offset:18432
    v_mfma_f32_32x32x16_bf16 v[64:79], v[32:35], v[28:31], v[64:79]
    ds_read_b64_tr_b16 v[166:167], v13 offset:18944
    s_waitcnt lgkmcnt(14)
    v_mfma_f32_32x32x16_bf16 v[176:191], v[192:195], v[128:131], 0
    v_mfma_f32_32x32x16_bf16 v[176:191], v[196:199], v[132:135], v[176:191]
    v_mfma_f32_32x32x16_bf16 v[80:95], v[52:55], v[44:47], v[80:95]
    v_mfma_f32_32x32x16_bf16 v[96:111], v[44:47], v[56:59], v[96:111]
    v_mfma_f32_32x32x16_bf16 v[64:79], v[48:51], v[44:47], v[64:79]
    s_waitcnt lgkmcnt(0)
    s_barrier
    v_mfma_f32_32x32x16_bf16 v[80:95], v[120:123], v[112:115], v[80:95]
    ds_read_b128 v[28:31], v8 offset:24576
    ds_read_b64_tr_b16 v[36:37], v13 offset:25600
    ds_read_b64_tr_b16 v[38:39], v13 offset:26112
    ds_read_b64_tr_b16 v[40:41], v13 offset:26624
    ds_read_b64_tr_b16 v[42:43], v13 offset:27136
    v_mfma_f32_32x32x16_bf16 v[96:111], v[112:115], v[124:127], v[96:111]
    ds_read_b64_tr_b16 v[32:33], v13 offset:24576
    ds_read_b64_tr_b16 v[34:35], v13 offset:25088
    ds_read_b128 v[44:47], v9 offset:24576
    ds_read_b64_tr_b16 v[52:53], v13 offset:31744
    ds_read_b64_tr_b16 v[54:55], v13 offset:32256
    v_mfma_f32_32x32x16_bf16 v[64:79], v[116:119], v[112:115], v[64:79]
    ds_read_b64_tr_b16 v[56:57], v13 offset:32768
    ds_read_b64_tr_b16 v[58:59], v13 offset:33280
    ds_read_b64_tr_b16 v[48:49], v13 offset:30720
    ds_read_b64_tr_b16 v[50:51], v13 offset:31232
    v_mfma_f32_32x32x16_bf16 v[80:95], v[168:171], v[160:163], v[80:95]
    ds_read_b128 v[112:115], v10 offset:24576
    ds_read_b64_tr_b16 v[120:121], v13 offset:37888
    ds_read_b64_tr_b16 v[122:123], v13 offset:38400
    v_mfma_f32_32x32x16_bf16 v[96:111], v[160:163], v[172:175], v[96:111]
    ds_read_b64_tr_b16 v[124:125], v13 offset:38912
    ds_read_b64_tr_b16 v[126:127], v13 offset:39424
    ds_read_b64_tr_b16 v[116:117], v13 offset:36864
    v_mfma_f32_32x32x16_bf16 v[64:79], v[164:167], v[160:163], v[64:79]
    ds_read_b64_tr_b16 v[118:119], v13 offset:37376
    s_waitcnt lgkmcnt(14)
    v_mfma_f32_32x32x16_bf16 v[80:95], v[36:39], v[28:31], v[80:95]
    ds_read_b128 v[160:163], v11 offset:24576
    ds_read_b64_tr_b16 v[168:169], v13 offset:44032
    ds_read_b64_tr_b16 v[170:171], v13 offset:44544
    v_mfma_f32_32x32x16_bf16 v[96:111], v[28:31], v[40:43], v[96:111]
    ds_read_b64_tr_b16 v[172:173], v13 offset:45056
    ds_read_b64_tr_b16 v[174:175], v13 offset:45568
    ds_read_b64_tr_b16 v[164:165], v13 offset:43008
    v_mfma_f32_32x32x16_bf16 v[64:79], v[32:35], v[28:31], v[64:79]
    ds_read_b64_tr_b16 v[166:167], v13 offset:43520
    s_waitcnt lgkmcnt(14)
    v_mfma_f32_32x32x16_bf16 v[176:191], v[200:203], v[136:139], v[176:191]
    v_mfma_f32_32x32x16_bf16 v[176:191], v[204:207], v[140:143], v[176:191]
    v_mfma_f32_32x32x16_bf16 v[80:95], v[52:55], v[44:47], v[80:95]
    v_mfma_f32_32x32x16_bf16 v[96:111], v[44:47], v[56:59], v[96:111]
    v_mfma_f32_32x32x16_bf16 v[64:79], v[48:51], v[44:47], v[64:79]
    s_waitcnt lgkmcnt(0)
    s_barrier
    v_mfma_f32_32x32x16_bf16 v[80:95], v[120:123], v[112:115], v[80:95]
    ds_read_b128 v[28:31], v4
    ds_read_b64_tr_b16 v[36:37], v63 offset:1024
    ds_read_b64_tr_b16 v[38:39], v63 offset:1536
    ds_read_b64_tr_b16 v[40:41], v63 offset:2048
    ds_read_b64_tr_b16 v[42:43], v63 offset:2560
    v_mfma_f32_32x32x16_bf16 v[96:111], v[112:115], v[124:127], v[96:111]
    ds_read_b64_tr_b16 v[32:33], v63 offset:0
    ds_read_b64_tr_b16 v[34:35], v63 offset:512
    ds_read_b128 v[44:47], v5
    ds_read_b64_tr_b16 v[52:53], v63 offset:7168
    ds_read_b64_tr_b16 v[54:55], v63 offset:7680
    v_mfma_f32_32x32x16_bf16 v[64:79], v[116:119], v[112:115], v[64:79]
    ds_read_b64_tr_b16 v[56:57], v63 offset:8192
    ds_read_b64_tr_b16 v[58:59], v63 offset:8704
    ds_read_b64_tr_b16 v[48:49], v63 offset:6144
    ds_read_b64_tr_b16 v[50:51], v63 offset:6656
    v_mfma_f32_32x32x16_bf16 v[80:95], v[168:171], v[160:163], v[80:95]
    ds_read_b128 v[112:115], v6
    ds_read_b64_tr_b16 v[120:121], v63 offset:13312
    ds_read_b64_tr_b16 v[122:123], v63 offset:13824
    v_mfma_f32_32x32x16_bf16 v[96:111], v[160:163], v[172:175], v[96:111]
    ds_read_b64_tr_b16 v[124:125], v63 offset:14336
    ds_read_b64_tr_b16 v[126:127], v63 offset:14848
    ds_read_b64_tr_b16 v[116:117], v63 offset:12288
    v_mfma_f32_32x32x16_bf16 v[64:79], v[164:167], v[160:163], v[64:79]
    ds_read_b64_tr_b16 v[118:119], v63 offset:12800
    s_waitcnt lgkmcnt(14)
    v_mfma_f32_32x32x16_bf16 v[80:95], v[36:39], v[28:31], v[80:95]
    ds_read_b128 v[160:163], v7
    ds_read_b64_tr_b16 v[168:169], v63 offset:19456
    ds_read_b64_tr_b16 v[170:171], v63 offset:19968
    v_mfma_f32_32x32x16_bf16 v[96:111], v[28:31], v[40:43], v[96:111]
    ds_read_b64_tr_b16 v[172:173], v63 offset:20480
    ds_read_b64_tr_b16 v[174:175], v63 offset:20992
    ds_read_b64_tr_b16 v[164:165], v63 offset:18432
    v_mfma_f32_32x32x16_bf16 v[64:79], v[32:35], v[28:31], v[64:79]
    ds_read_b64_tr_b16 v[166:167], v63 offset:18944
    s_waitcnt lgkmcnt(14)
    v_mfma_f32_32x32x16_bf16 v[176:191], v[208:211], v[144:147], v[176:191]
    v_mfma_f32_32x32x16_bf16 v[176:191], v[212:215], v[148:151], v[176:191]
    v_mfma_f32_32x32x16_bf16 v[80:95], v[52:55], v[44:47], v[80:95]
    v_mfma_f32_32x32x16_bf16 v[96:111], v[44:47], v[56:59], v[96:111]
    v_mfma_f32_32x32x16_bf16 v[64:79], v[48:51], v[44:47], v[64:79]
    s_waitcnt lgkmcnt(0)
    s_barrier
    v_mfma_f32_32x32x16_bf16 v[80:95], v[120:123], v[112:115], v[80:95]
    ds_read_b128 v[28:31], v8 offset:0
    ds_read_b64_tr_b16 v[36:37], v12 offset:1024
    ds_read_b64_tr_b16 v[38:39], v12 offset:1536
    ds_read_b64_tr_b16 v[40:41], v12 offset:2048
    ds_read_b64_tr_b16 v[42:43], v12 offset:2560
    v_mfma_f32_32x32x16_bf16 v[96:111], v[112:115], v[124:127], v[96:111]
    ds_read_b64_tr_b16 v[32:33], v12 offset:0
    ds_read_b64_tr_b16 v[34:35], v12 offset:512
    ds_read_b128 v[44:47], v9 offset:0
    ds_read_b64_tr_b16 v[52:53], v12 offset:7168
    ds_read_b64_tr_b16 v[54:55], v12 offset:7680
    v_mfma_f32_32x32x16_bf16 v[64:79], v[116:119], v[112:115], v[64:79]
    ds_read_b64_tr_b16 v[56:57], v12 offset:8192
    ds_read_b64_tr_b16 v[58:59], v12 offset:8704
    ds_read_b64_tr_b16 v[48:49], v12 offset:6144
    ds_read_b64_tr_b16 v[50:51], v12 offset:6656
    v_mfma_f32_32x32x16_bf16 v[80:95], v[168:171], v[160:163], v[80:95]
    ds_read_b128 v[112:115], v10 offset:0
    ds_read_b64_tr_b16 v[120:121], v12 offset:13312
    ds_read_b64_tr_b16 v[122:123], v12 offset:13824
    v_mfma_f32_32x32x16_bf16 v[96:111], v[160:163], v[172:175], v[96:111]
    ds_read_b64_tr_b16 v[124:125], v12 offset:14336
    ds_read_b64_tr_b16 v[126:127], v12 offset:14848
    ds_read_b64_tr_b16 v[116:117], v12 offset:12288
    v_mfma_f32_32x32x16_bf16 v[64:79], v[164:167], v[160:163], v[64:79]
    ds_read_b64_tr_b16 v[118:119], v12 offset:12800
    s_waitcnt lgkmcnt(14)
    v_mfma_f32_32x32x16_bf16 v[80:95], v[36:39], v[28:31], v[80:95]
    ds_read_b128 v[160:163], v11 offset:0
    ds_read_b64_tr_b16 v[168:169], v12 offset:19456
    ds_read_b64_tr_b16 v[170:171], v12 offset:19968
    v_mfma_f32_32x32x16_bf16 v[96:111], v[28:31], v[40:43], v[96:111]
    ds_read_b64_tr_b16 v[172:173], v12 offset:20480
    ds_read_b64_tr_b16 v[174:175], v12 offset:20992
    ds_read_b64_tr_b16 v[164:165], v12 offset:18432
    v_mfma_f32_32x32x16_bf16 v[64:79], v[32:35], v[28:31], v[64:79]
    ds_read_b64_tr_b16 v[166:167], v12 offset:18944
    s_waitcnt lgkmcnt(14)
    v_mfma_f32_32x32x16_bf16 v[176:191], v[216:219], v[152:155], v[176:191]
    v_mfma_f32_32x32x16_bf16 v[176:191], v[220:223], v[156:159], v[176:191]
    v_mfma_f32_32x32x16_bf16 v[80:95], v[52:55], v[44:47], v[80:95]
    v_mfma_f32_32x32x16_bf16 v[96:111], v[44:47], v[56:59], v[96:111]
    v_mfma_f32_32x32x16_bf16 v[64:79], v[48:51], v[44:47], v[64:79]
    s_waitcnt lgkmcnt(0)
    s_barrier
    v_mfma_f32_32x32x16_bf16 v[80:95], v[120:123], v[112:115], v[80:95]
    ds_read_b128 v[28:31], v8 offset:8192
    ds_read_b64_tr_b16 v[36:37], v12 offset:25600
    ds_read_b64_tr_b16 v[38:39], v12 offset:26112
    ds_read_b64_tr_b16 v[40:41], v12 offset:26624
    ds_read_b64_tr_b16 v[42:43], v12 offset:27136
    v_mfma_f32_32x32x16_bf16 v[96:111], v[112:115], v[124:127], v[96:111]
    ds_read_b64_tr_b16 v[32:33], v12 offset:24576
    ds_read_b64_tr_b16 v[34:35], v12 offset:25088
    ds_read_b128 v[44:47], v9 offset:8192
    ds_read_b64_tr_b16 v[52:53], v12 offset:31744
    ds_read_b64_tr_b16 v[54:55], v12 offset:32256
    v_mfma_f32_32x32x16_bf16 v[64:79], v[116:119], v[112:115], v[64:79]
    ds_read_b64_tr_b16 v[56:57], v12 offset:32768
    ds_read_b64_tr_b16 v[58:59], v12 offset:33280
    ds_read_b64_tr_b16 v[48:49], v12 offset:30720
    ds_read_b64_tr_b16 v[50:51], v12 offset:31232
    v_mfma_f32_32x32x16_bf16 v[80:95], v[168:171], v[160:163], v[80:95]
    ds_read_b128 v[112:115], v10 offset:8192
    ds_read_b64_tr_b16 v[120:121], v12 offset:37888
    ds_read_b64_tr_b16 v[122:123], v12 offset:38400
    v_mfma_f32_32x32x16_bf16 v[96:111], v[160:163], v[172:175], v[96:111]
    ds_read_b64_tr_b16 v[124:125], v12 offset:38912
    ds_read_b64_tr_b16 v[126:127], v12 offset:39424
    ds_read_b64_tr_b16 v[116:117], v12 offset:36864
    v_mfma_f32_32x32x16_bf16 v[64:79], v[164:167], v[160:163], v[64:79]
    ds_read_b64_tr_b16 v[118:119], v12 offset:37376
    s_waitcnt lgkmcnt(14)
    v_mfma_f32_32x32x16_bf16 v[80:95], v[36:39], v[28:31], v[80:95]
    ds_read_b128 v[160:163], v11 offset:8192
    ds_read_b64_tr_b16 v[168:169], v12 offset:44032
    ds_read_b64_tr_b16 v[170:171], v12 offset:44544
    v_mfma_f32_32x32x16_bf16 v[96:111], v[28:31], v[40:43], v[96:111]
    ds_read_b64_tr_b16 v[172:173], v12 offset:45056
    ds_read_b64_tr_b16 v[174:175], v12 offset:45568
    ds_read_b64_tr_b16 v[164:165], v12 offset:43008
    v_mfma_f32_32x32x16_bf16 v[64:79], v[32:35], v[28:31], v[64:79]
    ds_read_b64_tr_b16 v[166:167], v12 offset:43520
    s_waitcnt lgkmcnt(14)
    v_mfma_f32_32x32x16_bf16 v[80:95], v[52:55], v[44:47], v[80:95]
    s_xor_b32 exec_lo, s35, 1
    s_mov_b32 exec_hi, 0
    v_add_f32 v176, v176, v27
    s_mov_b64 exec, -1
    v_mfma_f32_32x32x16_bf16 v[96:111], v[44:47], v[56:59], v[96:111]
    v_mfma_f32_32x32x16_bf16 v[64:79], v[48:51], v[44:47], v[64:79]
    s_waitcnt lgkmcnt(0)
    s_barrier
    v_mfma_f32_32x32x16_bf16 v[80:95], v[120:123], v[112:115], v[80:95]
    ds_write_b128 v62, v[176:179] offset:0
    ds_write_b128 v62, v[180:183] offset:1024
    ds_write_b128 v62, v[184:187] offset:2048
    ds_write_b128 v62, v[188:191] offset:3072
    ds_read_b128 v[28:31], v8 offset:16384
    ds_read_b64_tr_b16 v[36:37], v13 offset:1024
    v_mfma_f32_32x32x16_bf16 v[96:111], v[112:115], v[124:127], v[96:111]
    ds_read_b64_tr_b16 v[38:39], v13 offset:1536
    ds_read_b64_tr_b16 v[40:41], v13 offset:2048
    ds_read_b64_tr_b16 v[42:43], v13 offset:2560
    ds_read_b64_tr_b16 v[32:33], v13 offset:0
    ds_read_b64_tr_b16 v[34:35], v13 offset:512
    ds_read_b128 v[44:47], v9 offset:16384
    v_mfma_f32_32x32x16_bf16 v[64:79], v[116:119], v[112:115], v[64:79]
    ds_read_b64_tr_b16 v[52:53], v13 offset:7168
    ds_read_b64_tr_b16 v[54:55], v13 offset:7680
    ds_read_b64_tr_b16 v[56:57], v13 offset:8192
    ds_read_b64_tr_b16 v[58:59], v13 offset:8704
    ds_read_b64_tr_b16 v[48:49], v13 offset:6144
    ds_read_b64_tr_b16 v[50:51], v13 offset:6656
    v_mfma_f32_32x32x16_bf16 v[80:95], v[168:171], v[160:163], v[80:95]
    ds_read_b128 v[112:115], v10 offset:16384
    ds_read_b64_tr_b16 v[120:121], v13 offset:13312
    ds_read_b64_tr_b16 v[122:123], v13 offset:13824
    v_mfma_f32_32x32x16_bf16 v[96:111], v[160:163], v[172:175], v[96:111]
    ds_read_b64_tr_b16 v[124:125], v13 offset:14336
    ds_read_b64_tr_b16 v[126:127], v13 offset:14848
    ds_read_b64_tr_b16 v[116:117], v13 offset:12288
    v_mfma_f32_32x32x16_bf16 v[64:79], v[164:167], v[160:163], v[64:79]
    ds_read_b64_tr_b16 v[118:119], v13 offset:12800
    s_waitcnt lgkmcnt(14)
    s_barrier
    v_mfma_f32_32x32x16_bf16 v[80:95], v[36:39], v[28:31], v[80:95]
    ds_read_b128 v[160:163], v11 offset:16384
    ds_read_b64_tr_b16 v[168:169], v13 offset:19456
    ds_read_b64_tr_b16 v[170:171], v13 offset:19968
    v_mfma_f32_32x32x16_bf16 v[96:111], v[28:31], v[40:43], v[96:111]
    ds_read_b64_tr_b16 v[172:173], v13 offset:20480
    ds_read_b64_tr_b16 v[174:175], v13 offset:20992
    ds_read_b64_tr_b16 v[164:165], v13 offset:18432
    v_mfma_f32_32x32x16_bf16 v[64:79], v[32:35], v[28:31], v[64:79]
    ds_read_b64_tr_b16 v[166:167], v13 offset:18944
    s_waitcnt lgkmcnt(7)
    v_mfma_f32_32x32x16_bf16 v[64:79], v[48:51], v[44:47], v[64:79]
    v_mfma_f32_32x32x16_bf16 v[64:79], v[116:119], v[112:115], v[64:79]
    s_waitcnt lgkmcnt(0)
    v_mfma_f32_32x32x16_bf16 v[64:79], v[164:167], v[160:163], v[64:79]
    v_mov_b32 v152, 0
    v_mov_b32 v153, 0
    v_mov_b32 v154, 0
    v_mov_b32 v155, 0
    v_mov_b32 v176, 0
    v_mfma_f32_32x32x16_bf16 v[80:95], v[52:55], v[44:47], v[80:95]
    v_mov_b32 v177, 0
    v_mov_b32 v178, 0
    v_mov_b32 v179, 0
    v_mov_b32 v192, 0
    v_mov_b32 v193, 0
    v_mfma_f32_32x32x16_bf16 v[80:95], v[120:123], v[112:115], v[80:95]
    v_mul_f32 v64, s51, v64
    v_mul_f32 v65, s51, v65
    v_mul_f32 v66, s51, v66
    v_mul_f32 v67, s51, v67
    v_mul_f32 v68, s51, v68
    v_mul_f32 v69, s51, v69
    v_mfma_f32_32x32x16_bf16 v[80:95], v[168:171], v[160:163], v[80:95]
    v_mul_f32 v70, s51, v70
    v_mul_f32 v71, s51, v71
    v_mul_f32 v72, s51, v72
    v_mul_f32 v73, s51, v73
    v_mul_f32 v74, s51, v74
    v_mul_f32 v75, s51, v75
    v_mfma_f32_32x32x16_bf16 v[96:111], v[44:47], v[56:59], v[96:111]
    v_mul_f32 v76, s51, v76
    v_mul_f32 v77, s51, v77
    v_mul_f32 v78, s51, v78
    v_mul_f32 v79, s51, v79
    v_cvt_pk_bf16_f32 v20, v64, v65
    v_cvt_pk_bf16_f32 v21, v66, v67
    v_mfma_f32_32x32x16_bf16 v[96:111], v[112:115], v[124:127], v[96:111]
    v_cvt_pk_bf16_f32 v22, v68, v69
    v_cvt_pk_bf16_f32 v23, v70, v71
    v_cvt_pk_bf16_f32 v24, v72, v73
    v_cvt_pk_bf16_f32 v25, v74, v75
    v_cvt_pk_bf16_f32 v26, v76, v77
    v_cvt_pk_bf16_f32 v27, v78, v79
    v_mfma_f32_32x32x16_bf16 v[96:111], v[160:163], v[172:175], v[96:111]
    buffer_store_dwordx4 v[20:23], v224, s[16:19], s32 offen sc1
    buffer_store_dwordx4 v[24:27], v224, s[16:19], s33 offen sc1
    v_cvt_pk_bf16_f32 v4, v80, v81
    v_cvt_pk_bf16_f32 v5, v82, v83
    v_cvt_pk_bf16_f32 v6, v84, v85
    v_cvt_pk_bf16_f32 v7, v86, v87
    v_cvt_pk_bf16_f32 v8, v88, v89
    v_cvt_pk_bf16_f32 v9, v90, v91
    v_cvt_pk_bf16_f32 v10, v92, v93
    v_cvt_pk_bf16_f32 v11, v94, v95
    buffer_store_dwordx4 v[4:7], v60, s[16:19], s34 offen sc1
    buffer_store_dwordx4 v[8:11], v60, s[16:19], s50 offen sc1
    v_cvt_pk_bf16_f32 v12, v96, v97
    v_cvt_pk_bf16_f32 v13, v98, v99
    v_cvt_pk_bf16_f32 v14, v100, v101
    v_cvt_pk_bf16_f32 v15, v102, v103
    v_cvt_pk_bf16_f32 v16, v104, v105
    v_cvt_pk_bf16_f32 v17, v106, v107
    v_cvt_pk_bf16_f32 v18, v108, v109
    v_cvt_pk_bf16_f32 v19, v110, v111
    buffer_store_dwordx4 v[12:15], v61, s[16:19], s34 offen offset:1024 sc1
    buffer_store_dwordx4 v[16:19], v61, s[16:19], s34 offen offset:1280 sc1
    v_mov_b32 v194, 0
    v_mov_b32 v195, 0
    v_mov_b32 v208, 0
    v_mov_b32 v209, 0
    v_mov_b32 v210, 0
    v_mov_b32 v211, 0
    v_mov_b32 v132, v234
    v_mov_b32 v133, v234
    v_mov_b32 v134, v234
    v_mov_b32 v135, v234
    v_mov_b32 v136, v234
    v_mov_b32 v137, v234
    v_mov_b32 v138, v234
    v_mov_b32 v139, v234
    v_mov_b32 v144, v234
    v_mov_b32 v145, v234
    v_mov_b32 v146, v234
    v_mov_b32 v147, v234
    v_mov_b32 v148, v234
    v_mov_b32 v149, v234
    v_mov_b32 v150, v234
    v_mov_b32 v151, v234
    s_barrier
    v_mov_b32 v64, 0
    v_mov_b32 v65, 0
    v_mov_b32 v66, 0
    v_mov_b32 v67, 0
    v_mov_b32 v68, 0
    v_mov_b32 v69, 0
    v_mov_b32 v70, 0
    v_mov_b32 v71, 0
    v_mov_b32 v72, 0
    v_mov_b32 v73, 0
    v_mov_b32 v74, 0
    v_mov_b32 v75, 0
    v_mov_b32 v76, 0
    v_mov_b32 v77, 0
    v_mov_b32 v78, 0
    v_mov_b32 v79, 0
    v_mov_b32 v80, 0
    v_mov_b32 v81, 0
    v_mov_b32 v82, 0
    v_mov_b32 v83, 0
    v_mov_b32 v84, 0
    v_mov_b32 v85, 0
    v_mov_b32 v86, 0
    v_mov_b32 v87, 0
    v_mov_b32 v88, 0
    v_mov_b32 v89, 0
    v_mov_b32 v90, 0
    v_mov_b32 v91, 0
    v_mov_b32 v92, 0
    v_mov_b32 v93, 0
    v_mov_b32 v94, 0
    v_mov_b32 v95, 0
    v_mov_b32 v96, 0
    v_mov_b32 v97, 0
    v_mov_b32 v98, 0
    v_mov_b32 v99, 0
    v_mov_b32 v100, 0
    v_mov_b32 v101, 0
    v_mov_b32 v102, 0
    v_mov_b32 v103, 0
    v_mov_b32 v104, 0
    v_mov_b32 v105, 0
    v_mov_b32 v106, 0
    v_mov_b32 v107, 0
    v_mov_b32 v108, 0
    v_mov_b32 v109, 0
    v_mov_b32 v110, 0
    v_mov_b32 v111, 0
    v_mov_b32 v112, 0
    v_mov_b32 v113, 0
    v_mov_b32 v114, 0
    v_mov_b32 v115, 0
    v_mov_b32 v116, 0
    v_mov_b32 v117, 0
    v_mov_b32 v118, 0
    v_mov_b32 v119, 0
    v_mov_b32 v120, 0
    v_mov_b32 v121, 0
    v_mov_b32 v122, 0
    v_mov_b32 v123, 0
    v_mov_b32 v124, 0
    v_mov_b32 v125, 0
    v_mov_b32 v126, 0
    v_mov_b32 v127, 0
    s_waitcnt vmcnt(0)
    v_mov_b32 v1, 0
    v_mov_b32 v2, s60
    s_mov_b64 exec, 1
    buffer_store_dword v2, v1, s[16:19], s65 offen sc1
    s_mov_b64 exec, -1
W_conv:
    s_mov_b64 exec, s[36:37]
    ds_read_b128 v[152:155], v227 offset:0
    s_mov_b64 exec, -1
    ds_read2_b32 v[156:157], v225 offset0:0 offset1:1
    ds_read2_b32 v[158:159], v225 offset0:2 offset1:3
    ds_read2_b32 v[160:161], v226 offset0:0 offset1:1
    ds_read2_b32 v[162:163], v226 offset0:2 offset1:3
    ds_read_b128 v[164:167], v227 offset:4608
    s_mov_b64 exec, s[36:37]
    ds_read_b128 v[176:179], v227 offset:64
    s_mov_b64 exec, -1
    ds_read2_b32 v[180:181], v225 offset0:8 offset1:9
    ds_read2_b32 v[182:183], v225 offset0:10 offset1:11
    ds_read2_b32 v[184:185], v226 offset0:8 offset1:9
    s_ashr_i32 s36, s36, 1
    s_ashr_i32 s37, s37, 1
    ds_read2_b32 v[186:187], v226 offset0:10 offset1:11
    ds_read_b128 v[188:191], v227 offset:4672
    s_mov_b64 exec, s[36:37]
    ds_read_b128 v[192:195], v227 offset:144
    s_mov_b64 exec, -1
    ds_read2_b32 v[196:197], v225 offset0:16 offset1:17
    ds_read2_b32 v[198:199], v225 offset0:18 offset1:19
    ds_read2_b32 v[200:201], v226 offset0:16 offset1:17
    ds_read2_b32 v[202:203], v226 offset0:18 offset1:19
    ds_read_b128 v[204:207], v227 offset:4752
    s_waitcnt lgkmcnt(12)
    v_mfma_f32_32x32x16_bf16 v[48:63], v[156:159], v[152:155], 0
    s_mov_b64 exec, s[36:37]
    ds_read_b128 v[208:211], v227 offset:208
    s_mov_b64 exec, -1
    ds_read2_b32 v[212:213], v225 offset0:24 offset1:25
    v_mfma_f32_32x32x16_bf16 v[32:47], v[160:163], v[152:155], 0
    ds_read2_b32 v[214:215], v225 offset0:26 offset1:27
    ds_read2_b32 v[216:217], v226 offset0:24 offset1:25
    s_ashr_i32 s36, s36, 1
    s_ashr_i32 s37, s37, 1
    v_mfma_f32_32x32x16_bf16 v[48:63], v[160:163], v[164:167], v[48:63]
    ds_read2_b32 v[218:219], v226 offset0:26 offset1:27
    ds_read_b128 v[220:223], v227 offset:4816
    s_waitcnt lgkmcnt(12)
    v_mfma_f32_32x32x16_bf16 v[48:63], v[180:183], v[176:179], v[48:63]
    s_mov_b64 exec, s[36:37]
    ds_read_b128 v[152:155], v227 offset:288
    s_mov_b64 exec, -1
    ds_read2_b32 v[156:157], v225 offset0:32 offset1:33
    v_mfma_f32_32x32x16_bf16 v[32:47], v[184:187], v[176:179], v[32:47]
    ds_read2_b32 v[158:159], v225 offset0:34 offset1:35
    ds_read2_b32 v[160:161], v226 offset0:32 offset1:33
    v_mfma_f32_32x32x16_bf16 v[48:63], v[184:187], v[188:191], v[48:63]
    ds_read2_b32 v[162:163], v226 offset0:34 offset1:35
    ds_read_b128 v[164:167], v227 offset:4896
    s_waitcnt lgkmcnt(12)
    v_mfma_f32_32x32x16_bf16 v[48:63], v[196:199], v[192:195], v[48:63]
    s_mov_b64 exec, s[36:37]
    ds_read_b128 v[176:179], v227 offset:352
    s_mov_b64 exec, -1
    ds_read2_b32 v[180:181], v225 offset0:40 offset1:41
    v_mfma_f32_32x32x16_bf16 v[32:47], v[200:203], v[192:195], v[32:47]
    ds_read2_b32 v[182:183], v225 offset0:42 offset1:43
    ds_read2_b32 v[184:185], v226 offset0:40 offset1:41
    s_ashr_i32 s36, s36, 1
    s_ashr_i32 s37, s37, 1
    v_mfma_f32_32x32x16_bf16 v[48:63], v[200:203], v[204:207], v[48:63]
    ds_read2_b32 v[186:187], v226 offset0:42 offset1:43
    ds_read_b128 v[188:191], v227 offset:4960
    s_waitcnt lgkmcnt(12)
    v_mfma_f32_32x32x16_bf16 v[48:63], v[212:215], v[208:211], v[48:63]
    s_mov_b64 exec, s[36:37]
    ds_read_b128 v[192:195], v227 offset:432
    s_mov_b64 exec, -1
    ds_read2_b32 v[196:197], v225 offset0:48 offset1:49
    v_mfma_f32_32x32x16_bf16 v[32:47], v[216:219], v[208:211], v[32:47]
    ds_read2_b32 v[198:199], v225 offset0:50 offset1:51
    ds_read2_b32 v[200:201], v226 offset0:48 offset1:49
    v_mfma_f32_32x32x16_bf16 v[48:63], v[216:219], v[220:223], v[48:63]
    ds_read2_b32 v[202:203], v226 offset0:50 offset1:51
    ds_read_b128 v[204:207], v227 offset:5040
    s_waitcnt lgkmcnt(12)
    v_mfma_f32_32x32x16_bf16 v[48:63], v[156:159], v[152:155], v[48:63]
    s_mov_b64 exec, s[36:37]
    ds_read_b128 v[208:211], v227 offset:496
    s_mov_b64 exec, -1
    ds_read2_b32 v[212:213], v225 offset0:56 offset1:57
    v_mfma_f32_32x32x16_bf16 v[32:47], v[160:163], v[152:155], v[32:47]
    ds_read2_b32 v[214:215], v225 offset0:58 offset1:59
    ds_read2_b32 v[216:217], v226 offset0:56 offset1:57
    s_ashr_i32 s36, s36, 1
    s_ashr_i32 s37, s37, 1
    v_mfma_f32_32x32x16_bf16 v[48:63], v[160:163], v[164:167], v[48:63]
    ds_read2_b32 v[218:219], v226 offset0:58 offset1:59
    ds_read_b128 v[220:223], v227 offset:5104
    s_waitcnt lgkmcnt(12)
    v_mfma_f32_32x32x16_bf16 v[48:63], v[180:183], v[176:179], v[48:63]
    s_mov_b64 exec, s[36:37]
    ds_read_b128 v[152:155], v227 offset:576
    s_mov_b64 exec, -1
    ds_read2_b32 v[156:157], v225 offset0:64 offset1:65
    v_mfma_f32_32x32x16_bf16 v[32:47], v[184:187], v[176:179], v[32:47]
    ds_read2_b32 v[158:159], v225 offset0:66 offset1:67
    ds_read2_b32 v[160:161], v226 offset0:64 offset1:65
    v_mfma_f32_32x32x16_bf16 v[48:63], v[184:187], v[188:191], v[48:63]
    ds_read2_b32 v[162:163], v226 offset0:66 offset1:67
    ds_read_b128 v[164:167], v227 offset:5184
    s_waitcnt lgkmcnt(12)
    v_mfma_f32_32x32x16_bf16 v[48:63], v[196:199], v[192:195], v[48:63]
    s_mov_b64 exec, s[36:37]
    ds_read_b128 v[176:179], v227 offset:640
    s_mov_b64 exec, -1
    ds_read2_b32 v[180:181], v225 offset0:72 offset1:73
    v_mfma_f32_32x32x16_bf16 v[32:47], v[200:203], v[192:195], v[32:47]
    ds_read2_b32 v[182:183], v225 offset0:74 offset1:75
    ds_read2_b32 v[184:185], v226 offset0:72 offset1:73
    s_ashr_i32 s36, s36, 1
    s_ashr_i32 s37, s37, 1
    v_mfma_f32_32x32x16_bf16 v[48:63], v[200:203], v[204:207], v[48:63]
    ds_read2_b32 v[186:187], v226 offset0:74 offset1:75
    ds_read_b128 v[188:191], v227 offset:5248
    s_waitcnt lgkmcnt(12)
    v_mfma_f32_32x32x16_bf16 v[48:63], v[212:215], v[208:211], v[48:63]
    s_mov_b64 exec, s[36:37]
    ds_read_b128 v[192:195], v227 offset:720
    s_mov_b64 exec, -1
    ds_read2_b32 v[196:197], v225 offset0:80 offset1:81
    v_mfma_f32_32x32x16_bf16 v[32:47], v[216:219], v[208:211], v[32:47]
    ds_read2_b32 v[198:199], v225 offset0:82 offset1:83
    ds_read2_b32 v[200:201], v226 offset0:80 offset1:81
    v_mfma_f32_32x32x16_bf16 v[48:63], v[216:219], v[220:223], v[48:63]
    ds_read2_b32 v[202:203], v226 offset0:82 offset1:83
    ds_read_b128 v[204:207], v227 offset:5328
    s_waitcnt lgkmcnt(12)
    v_mfma_f32_32x32x16_bf16 v[48:63], v[156:159], v[152:155], v[48:63]
    s_mov_b64 exec, s[36:37]
    ds_read_b128 v[208:211], v227 offset:784
    s_mov_b64 exec, -1
    ds_read2_b32 v[212:213], v225 offset0:88 offset1:89
    v_mfma_f32_32x32x16_bf16 v[32:47], v[160:163], v[152:155], v[32:47]
    ds_read2_b32 v[214:215], v225 offset0:90 offset1:91
    ds_read2_b32 v[216:217], v226 offset0:88 offset1:89
    s_ashr_i32 s36, s36, 1
    s_ashr_i32 s37, s37, 1
    v_mfma_f32_32x32x16_bf16 v[48:63], v[160:163], v[164:167], v[48:63]
    ds_read2_b32 v[218:219], v226 offset0:90 offset1:91
    ds_read_b128 v[220:223], v227 offset:5392
    s_waitcnt lgkmcnt(12)
    v_mfma_f32_32x32x16_bf16 v[48:63], v[180:183], v[176:179], v[48:63]
    s_mov_b64 exec, s[36:37]
    ds_read_b128 v[152:155], v227 offset:864
    s_mov_b64 exec, -1
    ds_read2_b32 v[156:157], v225 offset0:96 offset1:97
    v_mfma_f32_32x32x16_bf16 v[32:47], v[184:187], v[176:179], v[32:47]
    ds_read2_b32 v[158:159], v225 offset0:98 offset1:99
    ds_read2_b32 v[160:161], v226 offset0:96 offset1:97
    v_mfma_f32_32x32x16_bf16 v[48:63], v[184:187], v[188:191], v[48:63]
    ds_read2_b32 v[162:163], v226 offset0:98 offset1:99
    ds_read_b128 v[164:167], v227 offset:5472
    s_waitcnt lgkmcnt(12)
    v_mfma_f32_32x32x16_bf16 v[48:63], v[196:199], v[192:195], v[48:63]
    s_mov_b64 exec, s[36:37]
    ds_read_b128 v[176:179], v227 offset:928
    s_mov_b64 exec, -1
    ds_read2_b32 v[180:181], v225 offset0:104 offset1:105
    v_mfma_f32_32x32x16_bf16 v[32:47], v[200:203], v[192:195], v[32:47]
    ds_read2_b32 v[182:183], v225 offset0:106 offset1:107
    ds_read2_b32 v[184:185], v226 offset0:104 offset1:105
    s_ashr_i32 s36, s36, 1
    s_ashr_i32 s37, s37, 1
    v_mfma_f32_32x32x16_bf16 v[48:63], v[200:203], v[204:207], v[48:63]
    ds_read2_b32 v[186:187], v226 offset0:106 offset1:107
    ds_read_b128 v[188:191], v227 offset:5536
    s_waitcnt lgkmcnt(12)
    v_mfma_f32_32x32x16_bf16 v[48:63], v[212:215], v[208:211], v[48:63]
    s_mov_b64 exec, s[36:37]
    ds_read_b128 v[192:195], v227 offset:1008
    s_mov_b64 exec, -1
    ds_read2_b32 v[196:197], v225 offset0:112 offset1:113
    v_mfma_f32_32x32x16_bf16 v[32:47], v[216:219], v[208:211], v[32:47]
    ds_read2_b32 v[198:199], v225 offset0:114 offset1:115
    ds_read2_b32 v[200:201], v226 offset0:112 offset1:113
    v_mfma_f32_32x32x16_bf16 v[48:63], v[216:219], v[220:223], v[48:63]
    ds_read2_b32 v[202:203], v226 offset0:114 offset1:115
    ds_read_b128 v[204:207], v227 offset:5616
    s_waitcnt lgkmcnt(12)
    v_mfma_f32_32x32x16_bf16 v[48:63], v[156:159], v[152:155], v[48:63]
    s_mov_b64 exec, s[36:37]
    ds_read_b128 v[208:211], v227 offset:1072
    s_mov_b64 exec, -1
    ds_read2_b32 v[212:213], v225 offset0:120 offset1:121
    v_mfma_f32_32x32x16_bf16 v[32:47], v[160:163], v[152:155], v[32:47]
    ds_read2_b32 v[214:215], v225 offset0:122 offset1:123
    ds_read2_b32 v[216:217], v226 offset0:120 offset1:121
    s_ashr_i32 s36, s36, 1
    s_ashr_i32 s37, s37, 1
    v_mfma_f32_32x32x16_bf16 v[48:63], v[160:163], v[164:167], v[48:63]
    ds_read2_b32 v[218:219], v226 offset0:122 offset1:123
    ds_read_b128 v[220:223], v227 offset:5680
    s_waitcnt lgkmcnt(12)
    v_mfma_f32_32x32x16_bf16 v[48:63], v[180:183], v[176:179], v[48:63]
    v_mfma_f32_32x32x16_bf16 v[32:47], v[184:187], v[176:179], v[32:47]
    v_mfma_f32_32x32x16_bf16 v[48:63], v[184:187], v[188:191], v[48:63]
    s_waitcnt lgkmcnt(6)
    v_mfma_f32_32x32x16_bf16 v[48:63], v[196:199], v[192:195], v[48:63]
    v_mfma_f32_32x32x16_bf16 v[32:47], v[200:203], v[192:195], v[32:47]
    v_mfma_f32_32x32x16_bf16 v[48:63], v[200:203], v[204:207], v[48:63]
    s_waitcnt lgkmcnt(0)
    v_mfma_f32_32x32x16_bf16 v[32:47], v[216:219], v[208:211], v[32:47]
    v_mfma_f32_32x32x16_bf16 v[48:63], v[212:215], v[208:211], v[48:63]
    v_mfma_f32_32x32x16_bf16 v[48:63], v[216:219], v[220:223], v[48:63]
    s_nop 9
    ds_write_b128 v228, v[32:35] offset:0
    ds_write_b128 v228, v[36:39] offset:1024
    ds_write_b128 v228, v[40:43] offset:8192
    ds_write_b128 v228, v[44:47] offset:9216
    ds_write_b128 v228, v[48:51] offset:16384
    ds_write_b128 v228, v[52:55] offset:17408
    ds_write_b128 v228, v[56:59] offset:24576
    ds_write_b128 v228, v[60:63] offset:25600
    s_cmp_eq_u32 s72, 0
    s_cbranch_scc1 W_done
    s_setprio 0
    s_lshl_b32 s6, s63, 6
    s_lshl_b32 s28, s64, 3
    s_add_u32 s6, s6, s28
    s_lshl_b32 s28, s67, 1
    s_add_u32 s6, s6, s28
    s_lshl_b32 s28, s6, 10
    v_lshlrev_b32 v3, 5, v0
    v_and_b32 v4, 0x3ff, v3
    buffer_load_dwordx4 v[8:11], v3, s[8:11], s28 offen
    buffer_load_dwordx4 v[12:15], v3, s[8:11], s28 offen offset:16
    global_load_dwordx4 v[16:19], v4, s[52:53]
    global_load_dwordx4 v[20:23], v4, s[52:53] offset:16
    v_mov_b32 v2, 159744
    s_cmp_lg_u32 s3, 4
    s_cbranch_scc1 W_lw
    buffer_load_dword v1, v255, s[16:19], 0 offen sc1
    s_mov_b32 s71, 200000
    s_branch SP2_chk
SP2:
    s_sleep 2
    buffer_load_dword v1, v255, s[16:19], 0 offen sc1
SP2_chk:
    s_waitcnt vmcnt(0)
    v_cmp_ne_u32 vcc, s60, v1
    s_sub_u32 s71, s71, 1
    s_nop 0
    s_cselect_b64 vcc, 0, vcc
    s_cbranch_vccnz SP2
    v_mov_b32 v1, 1
    ds_write_b32 v2, v1
    s_branch W_go
W_lw:
    s_mov_b32 s71, 1600000
W_lw2:
    s_sleep 1
    ds_read_b32 v1, v2
    s_waitcnt lgkmcnt(0)
    v_cmp_eq_u32 vcc, 0, v1
    s_sub_u32 s71, s71, 1
    s_nop 0
    s_cselect_b64 vcc, 0, vcc
    s_cbranch_vccnz W_lw2
W_go:
    s_lshl_b32 s29, s67, 10
    s_add_u32 m0, s29, 61440
    s_add_u32 s28, s45, 1024
    buffer_load_dwordx4 v224, s[16:19], s45 offen sc1 lds
    s_add_u32 m0, s29, 126976
    s_add_u32 s4, s39, 4096
    buffer_load_dwordx4 v224, s[16:19], s28 offen sc1 lds
    s_mov_b32 m0, s38
    s_nop 0
    buffer_load_dwordx4 v224, s[16:19], s39 offen sc1 lds
    buffer_load_dwordx4 v224, s[16:19], s39 offen offset:2048 sc1 lds
    s_add_u32 m0, s38, 4096
    s_nop 0
    buffer_load_dwordx4 v224, s[16:19], s4 offen sc1 lds
    buffer_load_dwordx4 v224, s[16:19], s4 offen offset:2048 sc1 lds
    s_waitcnt vmcnt(6)
    v_mov_b32 v5, 0
    v_dot2c_f32_bf16 v5, v8, v16
    v_dot2c_f32_bf16 v5, v9, v17
    v_dot2c_f32_bf16 v5, v10, v18
    v_dot2c_f32_bf16 v5, v11, v19
    v_dot2c_f32_bf16 v5, v12, v20
    v_dot2c_f32_bf16 v5, v13, v21
    v_dot2c_f32_bf16 v5, v14, v22
    v_dot2c_f32_bf16 v5, v15, v23
    s_nop 2
    v_add_f32_dpp v5, v5, v5 row_shr:1 row_mask:0xf bank_mask:0xf bound_ctrl:0
    s_nop 1
    v_add_f32_dpp v5, v5, v5 row_shr:2 row_mask:0xf bank_mask:0xf bound_ctrl:0
    s_nop 1
    v_add_f32_dpp v5, v5, v5 row_shr:4 row_mask:0xf bank_mask:0xf bound_ctrl:0
    s_nop 1
    v_add_f32_dpp v5, v5, v5 row_shr:8 row_mask:0xf bank_mask:0xf bound_ctrl:0
    s_nop 1
    v_add_f32_dpp v5, v5, v5 row_bcast:15 row_mask:0xa bank_mask:0xf
    v_cvt_pk_bf16_f32 v5, v5, v5
    v_lshlrev_b32 v5, 16, v5
    v_mul_f32 v5, 0xbfb8aa3b, v5
    v_exp_f32 v5, v5
    s_nop 0
    v_add_f32 v5, 1.0, v5
    v_rcp_f32 v5, v5
    s_nop 0
    v_cvt_pk_bf16_f32 v5, v5, v5
    v_lshlrev_b32 v12, 16, v5
    v_lshlrev_b32 v13, 2, v243
    s_lshl_b32 s6, s6, 2
    s_add_u32 s6, s6, 15728640
    s_mov_b32 exec_lo, 0x80000000
    s_mov_b32 exec_hi, 0x80000000
    buffer_store_dword v12, v13, s[16:19], s6 offen sc1
    s_mov_b64 exec, -1
W_done:
    s_waitcnt vmcnt(1) lgkmcnt(0)
    s_barrier
    ds_read_b128 v[4:7], v230 offset:61440
    ds_read_b128 v[8:11], v231 offset:61440
    ds_read_b128 v[128:131], v232 offset:0
    s_mov_b64 exec, s[30:31]
    ds_read_b128 v[132:135], v232 offset:1024
    ds_read_b128 v[136:139], v232 offset:1280
    s_mov_b64 exec, -1
    ds_read_b128 v[192:195], v229 offset:0
    ds_read_b128 v[196:199], v229 offset:1024
    ds_read_b128 v[200:203], v229 offset:2048
    ds_read_b128 v[204:207], v229 offset:3072
    ds_read_b128 v[208:211], v229 offset:4096
    ds_read_b128 v[212:215], v229 offset:5120
    ds_read_b128 v[216:219], v229 offset:6144
    ds_read_b128 v[220:223], v229 offset:7168
    v_mov_b32 v28, -1
    v_mov_b32 v29, -1
    v_mov_b32 v30, -1
    v_mov_b32 v31, -1
    s_waitcnt lgkmcnt(10)
    v_mfma_f32_32x32x16_bf16 v[32:47], v[128:131], v[4:7], v[96:111]
    s_waitcnt lgkmcnt(4)
    v_add_f32 v192, v192, v200
    v_add_f32 v193, v193, v201
    v_add_f32 v194, v194, v202
    v_add_f32 v195, v195, v203
    v_add_f32 v196, v196, v204
    v_add_f32 v197, v197, v205
    v_add_f32 v198, v198, v206
    v_add_f32 v199, v199, v207
    s_waitcnt lgkmcnt(0)
    v_add_f32 v208, v208, v216
    v_add_f32 v209, v209, v217
    v_add_f32 v210, v210, v218
    v_add_f32 v211, v211, v219
    v_add_f32 v212, v212, v220
    v_add_f32 v213, v213, v221
    v_add_f32 v214, v214, v222
    v_add_f32 v215, v215, v223
    v_add_f32 v192, v192, v208
    v_add_f32 v193, v193, v209
    v_add_f32 v194, v194, v210
    v_add_f32 v195, v195, v211
    v_add_f32 v196, v196, v212
    v_add_f32 v197, v197, v213
    v_add_f32 v198, v198, v214
    v_add_f32 v199, v199, v215
    v_cvt_pk_bf16_f32 v12, v192, v193
    v_cvt_pk_bf16_f32 v13, v194, v195
    v_cvt_pk_bf16_f32 v14, v196, v197
    v_cvt_pk_bf16_f32 v15, v198, v199
B_go:
    s_mov_b32 s49, s47
    s_mov_b32 m0, s40
    s_add_u32 s48, s41, 4096
    buffer_load_dwordx4 v224, s[16:19], s41 offen sc1 lds
    s_add_u32 m0, m0, 4096
.p2align 3
    v_exp_f32 v32, v32
    v_exp_f32 v33, v33
    ds_read_b128 v[140:143], v232 offset:2048
    s_mov_b64 exec, s[30:31]
    ds_read_b128 v[144:147], v232 offset:3072
    ds_read_b128 v[148:151], v232 offset:3328
    s_mov_b64 exec, -1
    v_exp_f32 v34, v34
    v_exp_f32 v35, v35
    v_exp_f32 v36, v36
    v_mfma_f32_32x32x16_bf16 v[48:63], v[128:131], v[8:11], v[112:127]
    v_exp_f32 v37, v37
    v_exp_f32 v38, v38
    v_exp_f32 v39, v39
    v_exp_f32 v40, v40
    v_exp_f32 v41, v41
    v_smfmac_f32_32x32x32_bf16 v[64:79], v[132:135], v[32:39], v233
    buffer_load_dwordx4 v224, s[16:19], s48 offen sc1 lds
    s_add_u32 s48, s48, 4096
    s_add_u32 m0, m0, 4096
    v_exp_f32 v42, v42
    v_exp_f32 v43, v43
    v_exp_f32 v44, v44
    v_exp_f32 v45, v45
    v_exp_f32 v46, v46
    v_exp_f32 v47, v47
    v_exp_f32 v48, v48
    v_exp_f32 v49, v49
    v_smfmac_f32_32x32x32_bf16 v[64:79], v[136:139], v[40:47], v233
    v_exp_f32 v50, v50
    v_exp_f32 v51, v51
    v_exp_f32 v52, v52
    s_waitcnt lgkmcnt(0)
    v_mfma_f32_32x32x16_bf16 v[32:47], v[140:143], v[4:7], v[96:111]
    v_exp_f32 v53, v53
    v_exp_f32 v54, v54
    v_exp_f32 v55, v55
    v_exp_f32 v56, v56
    v_exp_f32 v57, v57
    v_smfmac_f32_32x32x32_bf16 v[80:95], v[132:135], v[48:55], v233
    buffer_load_dwordx4 v224, s[16:19], s48 offen sc1 lds
    s_add_u32 s48, s48, 4096
    s_add_u32 m0, m0, 4096
    v_exp_f32 v58, v58
    v_exp_f32 v59, v59
    v_exp_f32 v60, v60
    v_exp_f32 v61, v61
    v_exp_f32 v62, v62
    v_exp_f32 v63, v63
    v_exp_f32 v32, v32
    v_exp_f32 v33, v33
    v_smfmac_f32_32x32x32_bf16 v[80:95], v[136:139], v[56:63], v233
    ds_read_b128 v[128:131], v232 offset:4096
    s_mov_b64 exec, s[30:31]
    ds_read_b128 v[132:135], v232 offset:5120
    ds_read_b128 v[136:139], v232 offset:5376
    s_mov_b64 exec, -1
    v_exp_f32 v34, v34
    v_exp_f32 v35, v35
    v_exp_f32 v36, v36
    v_mfma_f32_32x32x16_bf16 v[48:63], v[140:143], v[8:11], v[112:127]
    v_exp_f32 v37, v37
    v_exp_f32 v38, v38
    v_exp_f32 v39, v39
    v_exp_f32 v40, v40
    v_exp_f32 v41, v41
    v_smfmac_f32_32x32x32_bf16 v[64:79], v[144:147], v[32:39], v233
    buffer_load_dwordx4 v224, s[16:19], s48 offen sc1 lds
    s_add_u32 s48, s48, 4096
    s_add_u32 m0, m0, 4096
    v_exp_f32 v42, v42
    v_exp_f32 v43, v43
    v_exp_f32 v44, v44
    v_exp_f32 v45, v45
    v_exp_f32 v46, v46
    v_exp_f32 v47, v47
    v_exp_f32 v48, v48
    v_exp_f32 v49, v49
    v_smfmac_f32_32x32x32_bf16 v[64:79], v[148:151], v[40:47], v233
    v_exp_f32 v50, v50
    v_exp_f32 v51, v51
    v_exp_f32 v52, v52
    s_waitcnt lgkmcnt(0)
    v_mfma_f32_32x32x16_bf16 v[32:47], v[128:131], v[4:7], v[96:111]
    v_exp_f32 v53, v53
    v_exp_f32 v54, v54
    v_exp_f32 v55, v55
    v_exp_f32 v56, v56
    v_exp_f32 v57, v57
    v_smfmac_f32_32x32x32_bf16 v[80:95], v[144:147], v[48:55], v233
    buffer_load_dwordx4 v224, s[16:19], s48 offen sc1 lds
    s_add_u32 s48, s48, 4096
    s_add_u32 m0, m0, 4096
    v_exp_f32 v58, v58
    v_exp_f32 v59, v59
    v_exp_f32 v60, v60
    v_exp_f32 v61, v61
    v_exp_f32 v62, v62
    v_exp_f32 v63, v63
    v_exp_f32 v32, v32
    v_exp_f32 v33, v33
    v_smfmac_f32_32x32x32_bf16 v[80:95], v[148:151], v[56:63], v233
    ds_read_b128 v[140:143], v232 offset:6144
    s_mov_b64 exec, s[30:31]
    ds_read_b128 v[144:147], v232 offset:7168
    ds_read_b128 v[148:151], v232 offset:7424
    s_mov_b64 exec, -1
    v_exp_f32 v34, v34
    v_exp_f32 v35, v35
    v_exp_f32 v36, v36
    v_mfma_f32_32x32x16_bf16 v[48:63], v[128:131], v[8:11], v[112:127]
    v_exp_f32 v37, v37
    v_exp_f32 v38, v38
    v_exp_f32 v39, v39
    v_exp_f32 v40, v40
    v_exp_f32 v41, v41
    v_smfmac_f32_32x32x32_bf16 v[64:79], v[132:135], v[32:39], v233
    v_exp_f32 v42, v42
    v_exp_f32 v43, v43
    v_exp_f32 v44, v44
    v_exp_f32 v45, v45
    v_exp_f32 v46, v46
    v_exp_f32 v47, v47
    v_exp_f32 v48, v48
    v_exp_f32 v49, v49
    v_smfmac_f32_32x32x32_bf16 v[64:79], v[136:139], v[40:47], v233
    v_exp_f32 v50, v50
    v_exp_f32 v51, v51
    v_exp_f32 v52, v52
    s_waitcnt lgkmcnt(0)
    v_mfma_f32_32x32x16_bf16 v[32:47], v[140:143], v[4:7], v[96:111]
    v_exp_f32 v53, v53
    v_exp_f32 v54, v54
    v_exp_f32 v55, v55
    v_exp_f32 v56, v56
    v_exp_f32 v57, v57
    v_smfmac_f32_32x32x32_bf16 v[80:95], v[132:135], v[48:55], v233
    v_exp_f32 v58, v58
    v_exp_f32 v59, v59
    v_exp_f32 v60, v60
    v_exp_f32 v61, v61
    v_exp_f32 v62, v62
    v_exp_f32 v63, v63
    v_exp_f32 v32, v32
    v_exp_f32 v33, v33
    v_smfmac_f32_32x32x32_bf16 v[80:95], v[136:139], v[56:63], v233
    s_waitcnt vmcnt(2)
    s_barrier
    ds_read_b128 v[128:131], v232 offset:8192
    s_mov_b64 exec, s[30:31]
    ds_read_b128 v[132:135], v232 offset:9216
    ds_read_b128 v[136:139], v232 offset:9472
    s_mov_b64 exec, -1
    v_exp_f32 v34, v34
    v_exp_f32 v35, v35
    v_exp_f32 v36, v36
    v_mfma_f32_32x32x16_bf16 v[48:63], v[140:143], v[8:11], v[112:127]
    v_exp_f32 v37, v37
    v_exp_f32 v38, v38
    v_exp_f32 v39, v39
    v_exp_f32 v40, v40
    v_exp_f32 v41, v41
    v_smfmac_f32_32x32x32_bf16 v[64:79], v[144:147], v[32:39], v233
    buffer_load_dwordx4 v224, s[16:19], s48 offen sc1 lds
    s_add_u32 s48, s48, 4096
    s_add_u32 m0, m0, 4096
    v_exp_f32 v42, v42
    v_exp_f32 v43, v43
    v_exp_f32 v44, v44
    v_exp_f32 v45, v45
    v_exp_f32 v46, v46
    v_exp_f32 v47, v47
    v_exp_f32 v48, v48
    v_exp_f32 v49, v49
    v_smfmac_f32_32x32x32_bf16 v[64:79], v[148:151], v[40:47], v233
    v_exp_f32 v50, v50
    v_exp_f32 v51, v51
    v_exp_f32 v52, v52
    s_waitcnt lgkmcnt(0)
    v_mfma_f32_32x32x16_bf16 v[32:47], v[128:131], v[4:7], v[96:111]
    v_exp_f32 v53, v53
    v_exp_f32 v54, v54
    v_exp_f32 v55, v55
    v_exp_f32 v56, v56
    v_exp_f32 v57, v57
    v_smfmac_f32_32x32x32_bf16 v[80:95], v[144:147], v[48:55], v233
    buffer_load_dwordx4 v224, s[16:19], s48 offen sc1 lds
    s_add_u32 s48, s48, 4096
    s_add_u32 m0, m0, 4096
    v_exp_f32 v58, v58
    v_exp_f32 v59, v59
    v_exp_f32 v60, v60
    v_exp_f32 v61, v61
    v_exp_f32 v62, v62
    v_exp_f32 v63, v63
    v_exp_f32 v32, v32
    v_exp_f32 v33, v33
    v_smfmac_f32_32x32x32_bf16 v[80:95], v[148:151], v[56:63], v233
    ds_read_b128 v[140:143], v232 offset:10240
    s_mov_b64 exec, s[30:31]
    ds_read_b128 v[144:147], v232 offset:11264
    ds_read_b128 v[148:151], v232 offset:11520
    s_mov_b64 exec, -1
    v_exp_f32 v34, v34
    v_exp_f32 v35, v35
    v_exp_f32 v36, v36
    v_mfma_f32_32x32x16_bf16 v[48:63], v[128:131], v[8:11], v[112:127]
    v_exp_f32 v37, v37
    v_exp_f32 v38, v38
    v_exp_f32 v39, v39
    v_exp_f32 v40, v40
    v_exp_f32 v41, v41
    v_smfmac_f32_32x32x32_bf16 v[64:79], v[132:135], v[32:39], v233
    buffer_load_dwordx4 v224, s[16:19], s48 offen sc1 lds
    s_add_u32 s48, s48, 4096
    s_add_u32 m0, m0, 4096
    v_exp_f32 v42, v42
    v_exp_f32 v43, v43
    v_exp_f32 v44, v44
    v_exp_f32 v45, v45
    v_exp_f32 v46, v46
    v_exp_f32 v47, v47
    v_exp_f32 v48, v48
    v_exp_f32 v49, v49
    v_smfmac_f32_32x32x32_bf16 v[64:79], v[136:139], v[40:47], v233
    v_exp_f32 v50, v50
    v_exp_f32 v51, v51
    v_exp_f32 v52, v52
    s_waitcnt lgkmcnt(0)
    v_mfma_f32_32x32x16_bf16 v[32:47], v[140:143], v[4:7], v[96:111]
    v_exp_f32 v53, v53
    v_exp_f32 v54, v54
    v_exp_f32 v55, v55
    v_exp_f32 v56, v56
    v_exp_f32 v57, v57
    v_smfmac_f32_32x32x32_bf16 v[80:95], v[132:135], v[48:55], v233
    buffer_load_dwordx4 v224, s[16:19], s48 offen sc1 lds
    s_add_u32 s48, s48, 4096
    s_add_u32 m0, m0, 4096
    v_exp_f32 v58, v58
    v_exp_f32 v59, v59
    v_exp_f32 v60, v60
    v_exp_f32 v61, v61
    v_exp_f32 v62, v62
    v_exp_f32 v63, v63
    v_exp_f32 v32, v32
    v_exp_f32 v33, v33
    v_smfmac_f32_32x32x32_bf16 v[80:95], v[136:139], v[56:63], v233
    ds_read_b128 v[128:131], v232 offset:12288
    s_mov_b64 exec, s[30:31]
    ds_read_b128 v[132:135], v232 offset:13312
    ds_read_b128 v[136:139], v232 offset:13568
    s_mov_b64 exec, -1
    v_exp_f32 v34, v34
    v_exp_f32 v35, v35
    v_exp_f32 v36, v36
    v_mfma_f32_32x32x16_bf16 v[48:63], v[140:143], v[8:11], v[112:127]
    v_exp_f32 v37, v37
    v_exp_f32 v38, v38
    v_exp_f32 v39, v39
    v_exp_f32 v40, v40
    v_exp_f32 v41, v41
    v_smfmac_f32_32x32x32_bf16 v[64:79], v[144:147], v[32:39], v233
    buffer_load_dwordx4 v224, s[16:19], s48 offen sc1 lds
    s_add_u32 s48, s48, 4096
    s_add_u32 m0, m0, 4096
    v_exp_f32 v42, v42
    v_exp_f32 v43, v43
    v_exp_f32 v44, v44
    v_exp_f32 v45, v45
    v_exp_f32 v46, v46
    v_exp_f32 v47, v47
    v_exp_f32 v48, v48
    v_exp_f32 v49, v49
    v_smfmac_f32_32x32x32_bf16 v[64:79], v[148:151], v[40:47], v233
    v_exp_f32 v50, v50
    v_exp_f32 v51, v51
    v_exp_f32 v52, v52
    s_waitcnt lgkmcnt(0)
    v_mfma_f32_32x32x16_bf16 v[32:47], v[128:131], v[4:7], v[96:111]
    v_exp_f32 v53, v53
    v_exp_f32 v54, v54
    v_exp_f32 v55, v55
    v_exp_f32 v56, v56
    v_exp_f32 v57, v57
    v_smfmac_f32_32x32x32_bf16 v[80:95], v[144:147], v[48:55], v233
    buffer_load_dwordx4 v224, s[16:19], s48 offen sc1 lds
    s_add_u32 s48, s48, 4096
    s_add_u32 m0, m0, 4096
    v_exp_f32 v58, v58
    v_exp_f32 v59, v59
    v_exp_f32 v60, v60
    v_exp_f32 v61, v61
    v_exp_f32 v62, v62
    v_exp_f32 v63, v63
    v_exp_f32 v32, v32
    v_exp_f32 v33, v33
    v_smfmac_f32_32x32x32_bf16 v[80:95], v[148:151], v[56:63], v233
    ds_read_b128 v[140:143], v232 offset:14336
    s_mov_b64 exec, s[30:31]
    ds_read_b128 v[144:147], v232 offset:15360
    ds_read_b128 v[148:151], v232 offset:15616
    s_mov_b64 exec, -1
    v_exp_f32 v34, v34
    v_exp_f32 v35, v35
    v_exp_f32 v36, v36
    v_mfma_f32_32x32x16_bf16 v[48:63], v[128:131], v[8:11], v[112:127]
    v_exp_f32 v37, v37
    v_exp_f32 v38, v38
    v_exp_f32 v39, v39
    v_exp_f32 v40, v40
    v_exp_f32 v41, v41
    v_smfmac_f32_32x32x32_bf16 v[64:79], v[132:135], v[32:39], v233
    buffer_load_dwordx4 v224, s[16:19], s48 offen sc1 lds
    s_add_u32 s48, s48, 4096
    s_add_u32 m0, m0, 4096
    v_exp_f32 v42, v42
    v_exp_f32 v43, v43
    v_exp_f32 v44, v44
    v_exp_f32 v45, v45
    v_exp_f32 v46, v46
    v_exp_f32 v47, v47
    v_exp_f32 v48, v48
    v_exp_f32 v49, v49
    v_smfmac_f32_32x32x32_bf16 v[64:79], v[136:139], v[40:47], v233
    v_exp_f32 v50, v50
    v_exp_f32 v51, v51
    v_exp_f32 v52, v52
    s_waitcnt lgkmcnt(0)
    v_mfma_f32_32x32x16_bf16 v[32:47], v[140:143], v[4:7], v[96:111]
    v_exp_f32 v53, v53
    v_exp_f32 v54, v54
    v_exp_f32 v55, v55
    v_exp_f32 v56, v56
    v_exp_f32 v57, v57
    v_smfmac_f32_32x32x32_bf16 v[80:95], v[132:135], v[48:55], v233
    buffer_load_dwordx4 v224, s[16:19], s48 offen sc1 lds
    s_add_u32 s48, s48, 4096
    s_add_u32 m0, m0, 4096
    v_exp_f32 v58, v58
    v_exp_f32 v59, v59
    v_exp_f32 v60, v60
    v_exp_f32 v61, v61
    v_exp_f32 v62, v62
    v_exp_f32 v63, v63
    v_exp_f32 v32, v32
    v_exp_f32 v33, v33
    v_smfmac_f32_32x32x32_bf16 v[80:95], v[136:139], v[56:63], v233
    ds_read_b128 v[128:131], v232 offset:16384
    s_mov_b64 exec, s[30:31]
    ds_read_b128 v[132:135], v232 offset:17408
    ds_read_b128 v[136:139], v232 offset:17664
    s_mov_b64 exec, -1
    v_exp_f32 v34, v34
    v_exp_f32 v35, v35
    v_exp_f32 v36, v36
    v_mfma_f32_32x32x16_bf16 v[48:63], v[140:143], v[8:11], v[112:127]
    v_exp_f32 v37, v37
    v_exp_f32 v38, v38
    v_exp_f32 v39, v39
    v_exp_f32 v40, v40
    v_exp_f32 v41, v41
    v_smfmac_f32_32x32x32_bf16 v[64:79], v[144:147], v[32:39], v233
    buffer_load_dwordx4 v224, s[16:19], s48 offen sc1 lds
    s_mov_b32 m0, s42
    v_exp_f32 v42, v42
    v_exp_f32 v43, v43
    v_exp_f32 v44, v44
    v_exp_f32 v45, v45
    v_exp_f32 v46, v46
    v_exp_f32 v47, v47
    v_exp_f32 v48, v48
    v_exp_f32 v49, v49
    v_smfmac_f32_32x32x32_bf16 v[64:79], v[148:151], v[40:47], v233
    v_exp_f32 v50, v50
    v_exp_f32 v51, v51
    v_exp_f32 v52, v52
    s_waitcnt lgkmcnt(0)
    v_mfma_f32_32x32x16_bf16 v[32:47], v[128:131], v[4:7], v[96:111]
    v_exp_f32 v53, v53
    v_exp_f32 v54, v54
    v_exp_f32 v55, v55
    v_exp_f32 v56, v56
    v_exp_f32 v57, v57
    v_smfmac_f32_32x32x32_bf16 v[80:95], v[144:147], v[48:55], v233
    v_exp_f32 v58, v58
    v_exp_f32 v59, v59
    v_exp_f32 v60, v60
    v_exp_f32 v61, v61
    v_exp_f32 v62, v62
    v_exp_f32 v63, v63
    v_exp_f32 v32, v32
    v_exp_f32 v33, v33
    v_smfmac_f32_32x32x32_bf16 v[80:95], v[148:151], v[56:63], v233
    ds_read_b128 v[140:143], v232 offset:18432
    s_mov_b64 exec, s[30:31]
    ds_read_b128 v[144:147], v232 offset:19456
    ds_read_b128 v[148:151], v232 offset:19712
    s_mov_b64 exec, -1
    v_exp_f32 v34, v34
    v_exp_f32 v35, v35
    v_exp_f32 v36, v36
    v_mfma_f32_32x32x16_bf16 v[48:63], v[128:131], v[8:11], v[112:127]
    v_exp_f32 v37, v37
    v_exp_f32 v38, v38
    v_exp_f32 v39, v39
    v_exp_f32 v40, v40
    v_exp_f32 v41, v41
    v_smfmac_f32_32x32x32_bf16 v[64:79], v[132:135], v[32:39], v233
    buffer_load_dwordx4 v237, s[24:27], s49 offen offset:0 lds
    v_exp_f32 v42, v42
    v_exp_f32 v43, v43
    v_exp_f32 v44, v44
    v_exp_f32 v45, v45
    v_exp_f32 v46, v46
    v_exp_f32 v47, v47
    v_exp_f32 v48, v48
    v_exp_f32 v49, v49
    v_smfmac_f32_32x32x32_bf16 v[64:79], v[136:139], v[40:47], v233
    v_exp_f32 v50, v50
    v_exp_f32 v51, v51
    v_exp_f32 v52, v52
    s_waitcnt lgkmcnt(0)
    v_mfma_f32_32x32x16_bf16 v[32:47], v[140:143], v[4:7], v[96:111]
    v_exp_f32 v53, v53
    v_exp_f32 v54, v54
    v_exp_f32 v55, v55
    v_exp_f32 v56, v56
    v_exp_f32 v57, v57
    v_smfmac_f32_32x32x32_bf16 v[80:95], v[132:135], v[48:55], v233
    buffer_load_dwordx4 v238, s[24:27], s49 offen offset:1024 lds
    v_exp_f32 v58, v58
    v_exp_f32 v59, v59
    v_exp_f32 v60, v60
    v_exp_f32 v61, v61
    v_exp_f32 v62, v62
    v_exp_f32 v63, v63
    v_exp_f32 v32, v32
    v_exp_f32 v33, v33
    v_smfmac_f32_32x32x32_bf16 v[80:95], v[136:139], v[56:63], v233
    s_waitcnt vmcnt(2)
    s_barrier
    ds_read_b128 v[128:131], v232 offset:20480
    s_mov_b64 exec, s[30:31]
    ds_read_b128 v[132:135], v232 offset:21504
    ds_read_b128 v[136:139], v232 offset:21760
    s_mov_b64 exec, -1
    v_exp_f32 v34, v34
    v_exp_f32 v35, v35
    v_exp_f32 v36, v36
    v_mfma_f32_32x32x16_bf16 v[48:63], v[140:143], v[8:11], v[112:127]
    v_exp_f32 v37, v37
    v_exp_f32 v38, v38
    v_exp_f32 v39, v39
    v_exp_f32 v40, v40
    v_exp_f32 v41, v41
    v_smfmac_f32_32x32x32_bf16 v[64:79], v[144:147], v[32:39], v233
    buffer_load_dwordx4 v239, s[24:27], s49 offen offset:2048 lds
    v_exp_f32 v42, v42
    v_exp_f32 v43, v43
    v_exp_f32 v44, v44
    v_exp_f32 v45, v45
    v_exp_f32 v46, v46
    v_exp_f32 v47, v47
    v_exp_f32 v48, v48
    v_exp_f32 v49, v49
    v_smfmac_f32_32x32x32_bf16 v[64:79], v[148:151], v[40:47], v233
    v_exp_f32 v50, v50
    v_exp_f32 v51, v51
    v_exp_f32 v52, v52
    s_waitcnt lgkmcnt(0)
    v_mfma_f32_32x32x16_bf16 v[32:47], v[128:131], v[4:7], v[96:111]
    v_exp_f32 v53, v53
    v_exp_f32 v54, v54
    v_exp_f32 v55, v55
    v_exp_f32 v56, v56
    v_exp_f32 v57, v57
    v_smfmac_f32_32x32x32_bf16 v[80:95], v[144:147], v[48:55], v233
    buffer_load_dwordx4 v240, s[24:27], s49 offen offset:3072 lds
    s_add_u32 s49, s49, 32768
    v_exp_f32 v58, v58
    v_exp_f32 v59, v59
    v_exp_f32 v60, v60
    v_exp_f32 v61, v61
    v_exp_f32 v62, v62
    v_exp_f32 v63, v63
    v_exp_f32 v32, v32
    v_exp_f32 v33, v33
    v_smfmac_f32_32x32x32_bf16 v[80:95], v[148:151], v[56:63], v233
    ds_read_b128 v[140:143], v232 offset:22528
    s_mov_b64 exec, s[30:31]
    ds_read_b128 v[144:147], v232 offset:23552
    ds_read_b128 v[148:151], v232 offset:23808
    s_mov_b64 exec, -1
    v_exp_f32 v34, v34
    v_exp_f32 v35, v35
    v_exp_f32 v36, v36
    v_mfma_f32_32x32x16_bf16 v[48:63], v[128:131], v[8:11], v[112:127]
    v_exp_f32 v37, v37
    v_exp_f32 v38, v38
    v_exp_f32 v39, v39
    v_exp_f32 v40, v40
    v_exp_f32 v41, v41
    v_smfmac_f32_32x32x32_bf16 v[64:79], v[132:135], v[32:39], v233
    s_cmp_eq_u32 s70, 0
    s_cselect_b64 exec, -1, 0
    buffer_store_dwordx4 v[12:15], v235, s[16:19], s44 offen sc1
    s_mov_b64 exec, -1
    v_exp_f32 v42, v42
    v_exp_f32 v43, v43
    v_exp_f32 v44, v44
    v_exp_f32 v45, v45
    v_exp_f32 v46, v46
    v_exp_f32 v47, v47
    v_exp_f32 v48, v48
    v_exp_f32 v49, v49
    v_smfmac_f32_32x32x32_bf16 v[64:79], v[136:139], v[40:47], v233
    v_exp_f32 v50, v50
    v_exp_f32 v51, v51
    v_exp_f32 v52, v52
    s_waitcnt lgkmcnt(0)
    v_mfma_f32_32x32x16_bf16 v[32:47], v[140:143], v[4:7], v[96:111]
    v_exp_f32 v53, v53
    v_exp_f32 v54, v54
    v_exp_f32 v55, v55
    v_exp_f32 v56, v56
    v_exp_f32 v57, v57
    v_smfmac_f32_32x32x32_bf16 v[80:95], v[132:135], v[48:55], v233
    v_exp_f32 v58, v58
    v_exp_f32 v59, v59
    v_exp_f32 v60, v60
    v_exp_f32 v61, v61
    v_exp_f32 v62, v62
    v_exp_f32 v63, v63
    v_exp_f32 v32, v32
    v_exp_f32 v33, v33
    v_smfmac_f32_32x32x32_bf16 v[80:95], v[136:139], v[56:63], v233
    ds_read_b128 v[128:131], v232 offset:24576
    s_mov_b64 exec, s[30:31]
    ds_read_b128 v[132:135], v232 offset:25600
    ds_read_b128 v[136:139], v232 offset:25856
    s_mov_b64 exec, -1
    v_exp_f32 v34, v34
    v_exp_f32 v35, v35
    v_exp_f32 v36, v36
    v_mfma_f32_32x32x16_bf16 v[48:63], v[140:143], v[8:11], v[112:127]
    v_exp_f32 v37, v37
    v_exp_f32 v38, v38
    v_exp_f32 v39, v39
    v_exp_f32 v40, v40
    v_exp_f32 v41, v41
    v_smfmac_f32_32x32x32_bf16 v[64:79], v[144:147], v[32:39], v233
    s_cmp_eq_u32 s70, 0
    s_cselect_b64 exec, -1, 0
    buffer_store_dwordx4 v[28:31], v224, s[16:19], s43 offen sc1
    s_mov_b64 exec, -1
    v_exp_f32 v42, v42
    v_exp_f32 v43, v43
    v_exp_f32 v44, v44
    v_exp_f32 v45, v45
    v_exp_f32 v46, v46
    v_exp_f32 v47, v47
    v_exp_f32 v48, v48
    v_exp_f32 v49, v49
    v_smfmac_f32_32x32x32_bf16 v[64:79], v[148:151], v[40:47], v233
    v_exp_f32 v50, v50
    v_exp_f32 v51, v51
    v_exp_f32 v52, v52
    s_waitcnt lgkmcnt(0)
    v_mfma_f32_32x32x16_bf16 v[32:47], v[128:131], v[4:7], v[96:111]
    v_exp_f32 v53, v53
    v_exp_f32 v54, v54
    v_exp_f32 v55, v55
    v_exp_f32 v56, v56
    v_exp_f32 v57, v57
    v_smfmac_f32_32x32x32_bf16 v[80:95], v[144:147], v[48:55], v233
    v_exp_f32 v58, v58
    v_exp_f32 v59, v59
    v_exp_f32 v60, v60
    v_exp_f32 v61, v61
    v_exp_f32 v62, v62
    v_exp_f32 v63, v63
    v_exp_f32 v32, v32
    v_exp_f32 v33, v33
    v_smfmac_f32_32x32x32_bf16 v[80:95], v[148:151], v[56:63], v233
    s_waitcnt vmcnt(0)
    ds_read_b64_tr_b16 v[160:161], v236 offset:0
    ds_read_b64_tr_b16 v[162:163], v236 offset:1024
    ds_read_b64_tr_b16 v[164:165], v236 offset:64
    ds_read_b64_tr_b16 v[166:167], v236 offset:1088
    ds_read_b64_tr_b16 v[168:169], v236 offset:2048
    ds_read_b64_tr_b16 v[170:171], v236 offset:3072
    ds_read_b64_tr_b16 v[172:173], v236 offset:2112
    ds_read_b64_tr_b16 v[174:175], v236 offset:3136
    ds_read_b128 v[140:143], v232 offset:26624
    s_mov_b64 exec, s[30:31]
    ds_read_b128 v[144:147], v232 offset:27648
    ds_read_b128 v[148:151], v232 offset:27904
    s_mov_b64 exec, -1
    v_exp_f32 v34, v34
    v_exp_f32 v35, v35
    v_exp_f32 v36, v36
    v_mfma_f32_32x32x16_bf16 v[48:63], v[128:131], v[8:11], v[112:127]
    v_exp_f32 v37, v37
    v_exp_f32 v38, v38
    v_exp_f32 v39, v39
    v_exp_f32 v40, v40
    v_exp_f32 v41, v41
    v_smfmac_f32_32x32x32_bf16 v[64:79], v[132:135], v[32:39], v233
    v_exp_f32 v42, v42
    v_exp_f32 v43, v43
    v_exp_f32 v44, v44
    v_exp_f32 v45, v45
    v_exp_f32 v46, v46
    v_exp_f32 v47, v47
    v_exp_f32 v48, v48
    v_exp_f32 v49, v49
    v_smfmac_f32_32x32x32_bf16 v[64:79], v[136:139], v[40:47], v233
    v_exp_f32 v50, v50
    v_exp_f32 v51, v51
    v_exp_f32 v52, v52
    s_waitcnt lgkmcnt(0)
    v_mfma_f32_32x32x16_bf16 v[32:47], v[140:143], v[4:7], v[96:111]
    v_exp_f32 v53, v53
    v_exp_f32 v54, v54
    v_exp_f32 v55, v55
    v_exp_f32 v56, v56
    v_exp_f32 v57, v57
    v_smfmac_f32_32x32x32_bf16 v[80:95], v[132:135], v[48:55], v233
    v_exp_f32 v58, v58
    v_exp_f32 v59, v59
    v_exp_f32 v60, v60
    v_exp_f32 v61, v61
    v_exp_f32 v62, v62
    v_exp_f32 v63, v63
    v_exp_f32 v32, v32
    v_exp_f32 v33, v33
    v_smfmac_f32_32x32x32_bf16 v[80:95], v[136:139], v[56:63], v233
    ds_read_b128 v[128:131], v232 offset:28672
    s_mov_b64 exec, s[30:31]
    ds_read_b128 v[132:135], v232 offset:29696
    ds_read_b128 v[136:139], v232 offset:29952
    s_mov_b64 exec, -1
    v_exp_f32 v34, v34
    v_exp_f32 v35, v35
    v_exp_f32 v36, v36
    v_mfma_f32_32x32x16_bf16 v[48:63], v[140:143], v[8:11], v[112:127]
    v_exp_f32 v37, v37
    v_exp_f32 v38, v38
    v_exp_f32 v39, v39
    v_exp_f32 v40, v40
    v_exp_f32 v41, v41
    v_smfmac_f32_32x32x32_bf16 v[64:79], v[144:147], v[32:39], v233
    buffer_load_dwordx4 v237, s[24:27], s49 offen offset:0 lds
    v_exp_f32 v42, v42
    v_exp_f32 v43, v43
    v_exp_f32 v44, v44
    v_exp_f32 v45, v45
    v_exp_f32 v46, v46
    v_exp_f32 v47, v47
    v_exp_f32 v48, v48
    v_exp_f32 v49, v49
    v_smfmac_f32_32x32x32_bf16 v[64:79], v[148:151], v[40:47], v233
    v_exp_f32 v50, v50
    v_exp_f32 v51, v51
    v_exp_f32 v52, v52
    s_waitcnt lgkmcnt(0)
    v_mfma_f32_32x32x16_bf16 v[32:47], v[128:131], v[4:7], v[96:111]
    v_exp_f32 v53, v53
    v_exp_f32 v54, v54
    v_exp_f32 v55, v55
    v_exp_f32 v56, v56
    v_exp_f32 v57, v57
    v_smfmac_f32_32x32x32_bf16 v[80:95], v[144:147], v[48:55], v233
    buffer_load_dwordx4 v238, s[24:27], s49 offen offset:1024 lds
    v_exp_f32 v58, v58
    v_exp_f32 v59, v59
    v_exp_f32 v60, v60
    v_exp_f32 v61, v61
    v_exp_f32 v62, v62
    v_exp_f32 v63, v63
    v_exp_f32 v32, v32
    v_exp_f32 v33, v33
    v_smfmac_f32_32x32x32_bf16 v[80:95], v[148:151], v[56:63], v233
    ds_read_b128 v[140:143], v232 offset:30720
    s_mov_b64 exec, s[30:31]
    ds_read_b128 v[144:147], v232 offset:31744
    ds_read_b128 v[148:151], v232 offset:32000
    s_mov_b64 exec, -1
    v_exp_f32 v34, v34
    v_exp_f32 v35, v35
    v_exp_f32 v36, v36
    v_mfma_f32_32x32x16_bf16 v[48:63], v[128:131], v[8:11], v[112:127]
    v_exp_f32 v37, v37
    v_exp_f32 v38, v38
    v_exp_f32 v39, v39
    v_exp_f32 v40, v40
    v_exp_f32 v41, v41
    v_smfmac_f32_32x32x32_bf16 v[64:79], v[132:135], v[32:39], v233
    buffer_load_dwordx4 v239, s[24:27], s49 offen offset:2048 lds
    v_exp_f32 v42, v42
    v_exp_f32 v43, v43
    v_exp_f32 v44, v44
    v_exp_f32 v45, v45
    v_exp_f32 v46, v46
    v_exp_f32 v47, v47
    v_exp_f32 v48, v48
    v_exp_f32 v49, v49
    v_smfmac_f32_32x32x32_bf16 v[64:79], v[136:139], v[40:47], v233
    v_exp_f32 v50, v50
    v_exp_f32 v51, v51
    v_exp_f32 v52, v52
    s_waitcnt lgkmcnt(0)
    v_mfma_f32_32x32x16_bf16 v[32:47], v[140:143], v[4:7], v[96:111]
    v_exp_f32 v53, v53
    v_exp_f32 v54, v54
    v_exp_f32 v55, v55
    v_exp_f32 v56, v56
    v_exp_f32 v57, v57
    v_smfmac_f32_32x32x32_bf16 v[80:95], v[132:135], v[48:55], v233
    buffer_load_dwordx4 v240, s[24:27], s49 offen offset:3072 lds
    s_add_u32 s49, s49, 32768
    v_exp_f32 v58, v58
    v_exp_f32 v59, v59
    v_exp_f32 v60, v60
    v_exp_f32 v61, v61
    v_exp_f32 v62, v62
    v_exp_f32 v63, v63
    v_exp_f32 v32, v32
    v_exp_f32 v33, v33
    v_smfmac_f32_32x32x32_bf16 v[80:95], v[136:139], v[56:63], v233
    ds_read_b128 v[128:131], v232 offset:32768
    s_mov_b64 exec, s[30:31]
    ds_read_b128 v[132:135], v232 offset:33792
    ds_read_b128 v[136:139], v232 offset:34048
    s_mov_b64 exec, -1
    v_exp_f32 v34, v34
    v_exp_f32 v35, v35
    v_exp_f32 v36, v36
    v_mfma_f32_32x32x16_bf16 v[48:63], v[140:143], v[8:11], v[112:127]
    v_exp_f32 v37, v37
    v_exp_f32 v38, v38
    v_exp_f32 v39, v39
    v_exp_f32 v40, v40
    v_exp_f32 v41, v41
    v_smfmac_f32_32x32x32_bf16 v[64:79], v[144:147], v[32:39], v233
    v_exp_f32 v42, v42
    v_exp_f32 v43, v43
    v_exp_f32 v44, v44
    v_exp_f32 v45, v45
    v_exp_f32 v46, v46
    v_exp_f32 v47, v47
    v_exp_f32 v48, v48
    v_exp_f32 v49, v49
    v_smfmac_f32_32x32x32_bf16 v[64:79], v[148:151], v[40:47], v233
    v_exp_f32 v50, v50
    v_exp_f32 v51, v51
    v_exp_f32 v52, v52
    s_waitcnt lgkmcnt(0)
    v_mfma_f32_32x32x16_bf16 v[32:47], v[128:131], v[4:7], v[96:111]
    v_exp_f32 v53, v53
    v_exp_f32 v54, v54
    v_exp_f32 v55, v55
    v_exp_f32 v56, v56
    v_exp_f32 v57, v57
    v_smfmac_f32_32x32x32_bf16 v[80:95], v[144:147], v[48:55], v233
    v_exp_f32 v58, v58
    v_exp_f32 v59, v59
    v_exp_f32 v60, v60
    v_exp_f32 v61, v61
    v_exp_f32 v62, v62
    v_exp_f32 v63, v63
    v_exp_f32 v32, v32
    v_exp_f32 v33, v33
    v_smfmac_f32_32x32x32_bf16 v[80:95], v[148:151], v[56:63], v233
    ds_read_b128 v[140:143], v232 offset:34816
    s_mov_b64 exec, s[30:31]
    ds_read_b128 v[144:147], v232 offset:35840
    ds_read_b128 v[148:151], v232 offset:36096
    s_mov_b64 exec, -1
    v_exp_f32 v34, v34
    v_exp_f32 v35, v35
    v_exp_f32 v36, v36
    v_mfma_f32_32x32x16_bf16 v[48:63], v[128:131], v[8:11], v[112:127]
    v_exp_f32 v37, v37
    v_exp_f32 v38, v38
    v_exp_f32 v39, v39
    v_exp_f32 v40, v40
    v_exp_f32 v41, v41
    v_smfmac_f32_32x32x32_bf16 v[64:79], v[132:135], v[32:39], v233
    v_exp_f32 v42, v42
    v_exp_f32 v43, v43
    v_exp_f32 v44, v44
    v_exp_f32 v45, v45
    v_exp_f32 v46, v46
    v_exp_f32 v47, v47
    v_exp_f32 v48, v48
    v_exp_f32 v49, v49
    v_smfmac_f32_32x32x32_bf16 v[64:79], v[136:139], v[40:47], v233
    v_exp_f32 v50, v50
    v_exp_f32 v51, v51
    v_exp_f32 v52, v52
    s_waitcnt lgkmcnt(0)
    v_mfma_f32_32x32x16_bf16 v[32:47], v[140:143], v[4:7], v[96:111]
    v_exp_f32 v53, v53
    v_exp_f32 v54, v54
    v_exp_f32 v55, v55
    v_exp_f32 v56, v56
    v_exp_f32 v57, v57
    v_smfmac_f32_32x32x32_bf16 v[80:95], v[132:135], v[48:55], v233
    v_exp_f32 v58, v58
    v_exp_f32 v59, v59
    v_exp_f32 v60, v60
    v_exp_f32 v61, v61
    v_exp_f32 v62, v62
    v_exp_f32 v63, v63
    v_exp_f32 v32, v32
    v_exp_f32 v33, v33
    v_smfmac_f32_32x32x32_bf16 v[80:95], v[136:139], v[56:63], v233
    s_waitcnt vmcnt(0)
    s_barrier
    s_cmp_lg_u32 s3, 7
    s_cbranch_scc1 B_nof
    s_lshl_b32 s28, s63, 5
    s_lshl_b32 s29, s64, 2
    s_add_u32 s28, s28, s29
    s_add_u32 s28, s28, 15806464
    v_mov_b32 v1, 0
    v_mov_b32 v2, s60
    s_mov_b64 exec, 1
    buffer_store_dword v2, v1, s[16:19], s28 offen sc1
    s_mov_b64 exec, -1
B_nof:
    s_waitcnt vmcnt(0)
    ds_read_b64_tr_b16 v[176:177], v236 offset:0
    ds_read_b64_tr_b16 v[178:179], v236 offset:1024
    ds_read_b64_tr_b16 v[180:181], v236 offset:64
    ds_read_b64_tr_b16 v[182:183], v236 offset:1088
    ds_read_b64_tr_b16 v[184:185], v236 offset:2048
    ds_read_b64_tr_b16 v[186:187], v236 offset:3072
    ds_read_b64_tr_b16 v[188:189], v236 offset:2112
    ds_read_b64_tr_b16 v[190:191], v236 offset:3136
    ds_read_b128 v[128:131], v232 offset:36864
    s_mov_b64 exec, s[30:31]
    ds_read_b128 v[132:135], v232 offset:37888
    ds_read_b128 v[136:139], v232 offset:38144
    s_mov_b64 exec, -1
    v_exp_f32 v34, v34
    v_exp_f32 v35, v35
    v_exp_f32 v36, v36
    v_mfma_f32_32x32x16_bf16 v[48:63], v[140:143], v[8:11], v[112:127]
    v_exp_f32 v37, v37
    v_exp_f32 v38, v38
    v_exp_f32 v39, v39
    v_exp_f32 v40, v40
    v_exp_f32 v41, v41
    v_smfmac_f32_32x32x32_bf16 v[64:79], v[144:147], v[32:39], v233
    v_exp_f32 v42, v42
    v_exp_f32 v43, v43
    v_exp_f32 v44, v44
    v_exp_f32 v45, v45
    v_exp_f32 v46, v46
    v_exp_f32 v47, v47
    v_exp_f32 v48, v48
    v_exp_f32 v49, v49
    v_smfmac_f32_32x32x32_bf16 v[64:79], v[148:151], v[40:47], v233
    v_exp_f32 v50, v50
    v_exp_f32 v51, v51
    v_exp_f32 v52, v52
    s_waitcnt lgkmcnt(0)
    v_mfma_f32_32x32x16_bf16 v[32:47], v[128:131], v[4:7], v[96:111]
    v_exp_f32 v53, v53
    v_exp_f32 v54, v54
    v_exp_f32 v55, v55
    v_exp_f32 v56, v56
    v_exp_f32 v57, v57
    v_smfmac_f32_32x32x32_bf16 v[80:95], v[144:147], v[48:55], v233
    v_exp_f32 v58, v58
    v_exp_f32 v59, v59
    v_exp_f32 v60, v60
    v_exp_f32 v61, v61
    v_exp_f32 v62, v62
    v_exp_f32 v63, v63
    v_exp_f32 v32, v32
    v_exp_f32 v33, v33
    v_smfmac_f32_32x32x32_bf16 v[80:95], v[148:151], v[56:63], v233
    ds_read_b128 v[140:143], v232 offset:38912
    s_mov_b64 exec, s[30:31]
    ds_read_b128 v[144:147], v232 offset:39936
    ds_read_b128 v[148:151], v232 offset:40192
    s_mov_b64 exec, -1
    v_exp_f32 v34, v34
    v_exp_f32 v35, v35
    v_exp_f32 v36, v36
    v_mfma_f32_32x32x16_bf16 v[48:63], v[128:131], v[8:11], v[112:127]
    v_exp_f32 v37, v37
    v_exp_f32 v38, v38
    v_exp_f32 v39, v39
    v_exp_f32 v40, v40
    v_exp_f32 v41, v41
    v_smfmac_f32_32x32x32_bf16 v[64:79], v[132:135], v[32:39], v233
    buffer_load_dwordx4 v237, s[24:27], s49 offen offset:0 lds
    v_exp_f32 v42, v42
    v_exp_f32 v43, v43
    v_exp_f32 v44, v44
    v_exp_f32 v45, v45
    v_exp_f32 v46, v46
    v_exp_f32 v47, v47
    v_exp_f32 v48, v48
    v_exp_f32 v49, v49
    v_smfmac_f32_32x32x32_bf16 v[64:79], v[136:139], v[40:47], v233
    v_exp_f32 v50, v50
    v_exp_f32 v51, v51
    v_exp_f32 v52, v52
    s_waitcnt lgkmcnt(0)
    v_mfma_f32_32x32x16_bf16 v[32:47], v[140:143], v[4:7], v[96:111]
    v_exp_f32 v53, v53
    v_exp_f32 v54, v54
    v_exp_f32 v55, v55
    v_exp_f32 v56, v56
    v_exp_f32 v57, v57
    v_smfmac_f32_32x32x32_bf16 v[80:95], v[132:135], v[48:55], v233
    buffer_load_dwordx4 v238, s[24:27], s49 offen offset:1024 lds
    v_exp_f32 v58, v58
    v_exp_f32 v59, v59
    v_exp_f32 v60, v60
    v_exp_f32 v61, v61
    v_exp_f32 v62, v62
    v_exp_f32 v63, v63
    v_exp_f32 v32, v32
    v_exp_f32 v33, v33
    v_smfmac_f32_32x32x32_bf16 v[80:95], v[136:139], v[56:63], v233
    ds_read_b128 v[128:131], v232 offset:40960
    s_mov_b64 exec, s[30:31]
    ds_read_b128 v[132:135], v232 offset:41984
    ds_read_b128 v[136:139], v232 offset:42240
    s_mov_b64 exec, -1
    v_exp_f32 v34, v34
    v_exp_f32 v35, v35
    v_exp_f32 v36, v36
    v_mfma_f32_32x32x16_bf16 v[48:63], v[140:143], v[8:11], v[112:127]
    v_exp_f32 v37, v37
    v_exp_f32 v38, v38
    v_exp_f32 v39, v39
    v_exp_f32 v40, v40
    v_exp_f32 v41, v41
    v_smfmac_f32_32x32x32_bf16 v[64:79], v[144:147], v[32:39], v233
    buffer_load_dwordx4 v239, s[24:27], s49 offen offset:2048 lds
    v_exp_f32 v42, v42
    v_exp_f32 v43, v43
    v_exp_f32 v44, v44
    v_exp_f32 v45, v45
    v_exp_f32 v46, v46
    v_exp_f32 v47, v47
    v_exp_f32 v48, v48
    v_exp_f32 v49, v49
    v_smfmac_f32_32x32x32_bf16 v[64:79], v[148:151], v[40:47], v233
    v_exp_f32 v50, v50
    v_exp_f32 v51, v51
    v_exp_f32 v52, v52
    s_waitcnt lgkmcnt(0)
    v_mfma_f32_32x32x16_bf16 v[32:47], v[128:131], v[4:7], v[96:111]
    v_exp_f32 v53, v53
    v_exp_f32 v54, v54
    v_exp_f32 v55, v55
    v_exp_f32 v56, v56
    v_exp_f32 v57, v57
    v_smfmac_f32_32x32x32_bf16 v[80:95], v[144:147], v[48:55], v233
    buffer_load_dwordx4 v240, s[24:27], s49 offen offset:3072 lds
    s_add_u32 s49, s49, 32768
    v_exp_f32 v58, v58
    v_exp_f32 v59, v59
    v_exp_f32 v60, v60
    v_exp_f32 v61, v61
    v_exp_f32 v62, v62
    v_exp_f32 v63, v63
    v_exp_f32 v32, v32
    v_exp_f32 v33, v33
    v_smfmac_f32_32x32x32_bf16 v[80:95], v[148:151], v[56:63], v233
    ds_read_b128 v[140:143], v232 offset:43008
    s_mov_b64 exec, s[30:31]
    ds_read_b128 v[144:147], v232 offset:44032
    ds_read_b128 v[148:151], v232 offset:44288
    s_mov_b64 exec, -1
    v_exp_f32 v34, v34
    v_exp_f32 v35, v35
    v_exp_f32 v36, v36
    v_mfma_f32_32x32x16_bf16 v[48:63], v[128:131], v[8:11], v[112:127]
    v_exp_f32 v37, v37
    v_exp_f32 v38, v38
    v_exp_f32 v39, v39
    v_exp_f32 v40, v40
    v_exp_f32 v41, v41
    v_smfmac_f32_32x32x32_bf16 v[64:79], v[132:135], v[32:39], v233
    v_exp_f32 v42, v42
    v_exp_f32 v43, v43
    v_exp_f32 v44, v44
    v_exp_f32 v45, v45
    v_exp_f32 v46, v46
    v_exp_f32 v47, v47
    v_exp_f32 v48, v48
    v_exp_f32 v49, v49
    v_smfmac_f32_32x32x32_bf16 v[64:79], v[136:139], v[40:47], v233
    v_exp_f32 v50, v50
    v_exp_f32 v51, v51
    v_exp_f32 v52, v52
    s_waitcnt lgkmcnt(0)
    v_mfma_f32_32x32x16_bf16 v[32:47], v[140:143], v[4:7], v[96:111]
    v_exp_f32 v53, v53
    v_exp_f32 v54, v54
    v_exp_f32 v55, v55
    v_exp_f32 v56, v56
    v_exp_f32 v57, v57
    v_smfmac_f32_32x32x32_bf16 v[80:95], v[132:135], v[48:55], v233
    v_exp_f32 v58, v58
    v_exp_f32 v59, v59
    v_exp_f32 v60, v60
    v_exp_f32 v61, v61
    v_exp_f32 v62, v62
    v_exp_f32 v63, v63
    v_exp_f32 v32, v32
    v_exp_f32 v33, v33
    v_smfmac_f32_32x32x32_bf16 v[80:95], v[136:139], v[56:63], v233
    ds_read_b128 v[128:131], v232 offset:45056
    s_mov_b64 exec, s[30:31]
    ds_read_b128 v[132:135], v232 offset:46080
    ds_read_b128 v[136:139], v232 offset:46336
    s_mov_b64 exec, -1
    v_exp_f32 v34, v34
    v_exp_f32 v35, v35
    v_exp_f32 v36, v36
    v_mfma_f32_32x32x16_bf16 v[48:63], v[140:143], v[8:11], v[112:127]
    v_exp_f32 v37, v37
    v_exp_f32 v38, v38
    v_exp_f32 v39, v39
    v_exp_f32 v40, v40
    v_exp_f32 v41, v41
    v_smfmac_f32_32x32x32_bf16 v[64:79], v[144:147], v[32:39], v233
    v_exp_f32 v42, v42
    v_exp_f32 v43, v43
    v_exp_f32 v44, v44
    v_exp_f32 v45, v45
    v_exp_f32 v46, v46
    v_exp_f32 v47, v47
    v_exp_f32 v48, v48
    v_exp_f32 v49, v49
    v_smfmac_f32_32x32x32_bf16 v[64:79], v[148:151], v[40:47], v233
    v_exp_f32 v50, v50
    v_exp_f32 v51, v51
    v_exp_f32 v52, v52
    s_waitcnt lgkmcnt(0)
    v_mfma_f32_32x32x16_bf16 v[32:47], v[128:131], v[4:7], v[96:111]
    v_exp_f32 v53, v53
    v_exp_f32 v54, v54
    v_exp_f32 v55, v55
    v_exp_f32 v56, v56
    v_exp_f32 v57, v57
    v_smfmac_f32_32x32x32_bf16 v[80:95], v[144:147], v[48:55], v233
    v_exp_f32 v58, v58
    v_exp_f32 v59, v59
    v_exp_f32 v60, v60
    v_exp_f32 v61, v61
    v_exp_f32 v62, v62
    v_exp_f32 v63, v63
    v_exp_f32 v32, v32
    v_exp_f32 v33, v33
    v_smfmac_f32_32x32x32_bf16 v[80:95], v[148:151], v[56:63], v233
    s_waitcnt vmcnt(0)
    ds_read_b64_tr_b16 v[192:193], v236 offset:0
    ds_read_b64_tr_b16 v[194:195], v236 offset:1024
    ds_read_b64_tr_b16 v[196:197], v236 offset:64
    ds_read_b64_tr_b16 v[198:199], v236 offset:1088
    ds_read_b64_tr_b16 v[200:201], v236 offset:2048
    ds_read_b64_tr_b16 v[202:203], v236 offset:3072
    ds_read_b64_tr_b16 v[204:205], v236 offset:2112
    ds_read_b64_tr_b16 v[206:207], v236 offset:3136
    ds_read_b128 v[140:143], v232 offset:47104
    s_mov_b64 exec, s[30:31]
    ds_read_b128 v[144:147], v232 offset:48128
    ds_read_b128 v[148:151], v232 offset:48384
    s_mov_b64 exec, -1
    v_exp_f32 v34, v34
    v_exp_f32 v35, v35
    v_exp_f32 v36, v36
    v_mfma_f32_32x32x16_bf16 v[48:63], v[128:131], v[8:11], v[112:127]
    v_exp_f32 v37, v37
    v_exp_f32 v38, v38
    v_exp_f32 v39, v39
    v_exp_f32 v40, v40
    v_exp_f32 v41, v41
    v_smfmac_f32_32x32x32_bf16 v[64:79], v[132:135], v[32:39], v233
    v_exp_f32 v42, v42
    v_exp_f32 v43, v43
    v_exp_f32 v44, v44
    v_exp_f32 v45, v45
    v_exp_f32 v46, v46
    v_exp_f32 v47, v47
    v_exp_f32 v48, v48
    v_exp_f32 v49, v49
    v_smfmac_f32_32x32x32_bf16 v[64:79], v[136:139], v[40:47], v233
    v_exp_f32 v50, v50
    v_exp_f32 v51, v51
    v_exp_f32 v52, v52
    s_waitcnt lgkmcnt(0)
    v_mfma_f32_32x32x16_bf16 v[32:47], v[140:143], v[4:7], v[96:111]
    v_exp_f32 v53, v53
    v_exp_f32 v54, v54
    v_exp_f32 v55, v55
    v_exp_f32 v56, v56
    v_exp_f32 v57, v57
    v_smfmac_f32_32x32x32_bf16 v[80:95], v[132:135], v[48:55], v233
    v_exp_f32 v58, v58
    v_exp_f32 v59, v59
    v_exp_f32 v60, v60
    v_exp_f32 v61, v61
    v_exp_f32 v62, v62
    v_exp_f32 v63, v63
    v_exp_f32 v32, v32
    v_exp_f32 v33, v33
    v_smfmac_f32_32x32x32_bf16 v[80:95], v[136:139], v[56:63], v233
    ds_read_b128 v[128:131], v232 offset:49152
    s_mov_b64 exec, s[30:31]
    ds_read_b128 v[132:135], v232 offset:50176
    ds_read_b128 v[136:139], v232 offset:50432
    s_mov_b64 exec, -1
    v_exp_f32 v34, v34
    v_exp_f32 v35, v35
    v_exp_f32 v36, v36
    v_mfma_f32_32x32x16_bf16 v[48:63], v[140:143], v[8:11], v[112:127]
    v_exp_f32 v37, v37
    v_exp_f32 v38, v38
    v_exp_f32 v39, v39
    v_exp_f32 v40, v40
    v_exp_f32 v41, v41
    v_smfmac_f32_32x32x32_bf16 v[64:79], v[144:147], v[32:39], v233
    buffer_load_dwordx4 v237, s[24:27], s49 offen offset:0 lds
    v_exp_f32 v42, v42
    v_exp_f32 v43, v43
    v_exp_f32 v44, v44
    v_exp_f32 v45, v45
    v_exp_f32 v46, v46
    v_exp_f32 v47, v47
    v_exp_f32 v48, v48
    v_exp_f32 v49, v49
    v_smfmac_f32_32x32x32_bf16 v[64:79], v[148:151], v[40:47], v233
    v_exp_f32 v50, v50
    v_exp_f32 v51, v51
    v_exp_f32 v52, v52
    s_waitcnt lgkmcnt(0)
    v_mfma_f32_32x32x16_bf16 v[32:47], v[128:131], v[4:7], v[96:111]
    v_exp_f32 v53, v53
    v_exp_f32 v54, v54
    v_exp_f32 v55, v55
    v_exp_f32 v56, v56
    v_exp_f32 v57, v57
    v_smfmac_f32_32x32x32_bf16 v[80:95], v[144:147], v[48:55], v233
    buffer_load_dwordx4 v238, s[24:27], s49 offen offset:1024 lds
    v_exp_f32 v58, v58
    v_exp_f32 v59, v59
    v_exp_f32 v60, v60
    v_exp_f32 v61, v61
    v_exp_f32 v62, v62
    v_exp_f32 v63, v63
    v_exp_f32 v32, v32
    v_exp_f32 v33, v33
    v_smfmac_f32_32x32x32_bf16 v[80:95], v[148:151], v[56:63], v233
    ds_read_b128 v[140:143], v232 offset:51200
    s_mov_b64 exec, s[30:31]
    ds_read_b128 v[144:147], v232 offset:52224
    ds_read_b128 v[148:151], v232 offset:52480
    s_mov_b64 exec, -1
    v_exp_f32 v34, v34
    v_exp_f32 v35, v35
    v_exp_f32 v36, v36
    v_mfma_f32_32x32x16_bf16 v[48:63], v[128:131], v[8:11], v[112:127]
    v_exp_f32 v37, v37
    v_exp_f32 v38, v38
    v_exp_f32 v39, v39
    v_exp_f32 v40, v40
    v_exp_f32 v41, v41
    v_smfmac_f32_32x32x32_bf16 v[64:79], v[132:135], v[32:39], v233
    buffer_load_dwordx4 v239, s[24:27], s49 offen offset:2048 lds
    v_exp_f32 v42, v42
    v_exp_f32 v43, v43
    v_exp_f32 v44, v44
    v_exp_f32 v45, v45
    v_exp_f32 v46, v46
    v_exp_f32 v47, v47
    v_exp_f32 v48, v48
    v_exp_f32 v49, v49
    v_smfmac_f32_32x32x32_bf16 v[64:79], v[136:139], v[40:47], v233
    v_exp_f32 v50, v50
    v_exp_f32 v51, v51
    v_exp_f32 v52, v52
    s_waitcnt lgkmcnt(0)
    v_mfma_f32_32x32x16_bf16 v[32:47], v[140:143], v[4:7], v[96:111]
    v_exp_f32 v53, v53
    v_exp_f32 v54, v54
    v_exp_f32 v55, v55
    v_exp_f32 v56, v56
    v_exp_f32 v57, v57
    v_smfmac_f32_32x32x32_bf16 v[80:95], v[132:135], v[48:55], v233
    buffer_load_dwordx4 v240, s[24:27], s49 offen offset:3072 lds
    s_add_u32 s49, s49, 32768
    v_exp_f32 v58, v58
    v_exp_f32 v59, v59
    v_exp_f32 v60, v60
    v_exp_f32 v61, v61
    v_exp_f32 v62, v62
    v_exp_f32 v63, v63
    v_exp_f32 v32, v32
    v_exp_f32 v33, v33
    v_smfmac_f32_32x32x32_bf16 v[80:95], v[136:139], v[56:63], v233
    ds_read_b128 v[128:131], v232 offset:53248
    s_mov_b64 exec, s[30:31]
    ds_read_b128 v[132:135], v232 offset:54272
    ds_read_b128 v[136:139], v232 offset:54528
    s_mov_b64 exec, -1
    v_exp_f32 v34, v34
    v_exp_f32 v35, v35
    v_exp_f32 v36, v36
    v_mfma_f32_32x32x16_bf16 v[48:63], v[140:143], v[8:11], v[112:127]
    v_exp_f32 v37, v37
    v_exp_f32 v38, v38
    v_exp_f32 v39, v39
    v_exp_f32 v40, v40
    v_exp_f32 v41, v41
    v_smfmac_f32_32x32x32_bf16 v[64:79], v[144:147], v[32:39], v233
    buffer_load_dword v18, v241, s[16:19], 0 offen sc1
    v_exp_f32 v42, v42
    v_exp_f32 v43, v43
    v_exp_f32 v44, v44
    v_exp_f32 v45, v45
    v_exp_f32 v46, v46
    v_exp_f32 v47, v47
    v_exp_f32 v48, v48
    v_exp_f32 v49, v49
    v_smfmac_f32_32x32x32_bf16 v[64:79], v[148:151], v[40:47], v233
    v_exp_f32 v50, v50
    v_exp_f32 v51, v51
    v_exp_f32 v52, v52
    s_waitcnt lgkmcnt(0)
    v_mfma_f32_32x32x16_bf16 v[32:47], v[128:131], v[4:7], v[96:111]
    v_exp_f32 v53, v53
    v_exp_f32 v54, v54
    v_exp_f32 v55, v55
    v_exp_f32 v56, v56
    v_exp_f32 v57, v57
    v_smfmac_f32_32x32x32_bf16 v[80:95], v[144:147], v[48:55], v233
    v_exp_f32 v58, v58
    v_exp_f32 v59, v59
    v_exp_f32 v60, v60
    v_exp_f32 v61, v61
    v_exp_f32 v62, v62
    v_exp_f32 v63, v63
    v_exp_f32 v32, v32
    v_exp_f32 v33, v33
    v_smfmac_f32_32x32x32_bf16 v[80:95], v[148:151], v[56:63], v233
    ds_read_b128 v[140:143], v232 offset:55296
    s_mov_b64 exec, s[30:31]
    ds_read_b128 v[144:147], v232 offset:56320
    ds_read_b128 v[148:151], v232 offset:56576
    s_mov_b64 exec, -1
    v_exp_f32 v34, v34
    v_exp_f32 v35, v35
    v_exp_f32 v36, v36
    v_mfma_f32_32x32x16_bf16 v[48:63], v[128:131], v[8:11], v[112:127]
    v_exp_f32 v37, v37
    v_exp_f32 v38, v38
    v_exp_f32 v39, v39
    v_exp_f32 v40, v40
    v_exp_f32 v41, v41
    v_smfmac_f32_32x32x32_bf16 v[64:79], v[132:135], v[32:39], v233
    v_exp_f32 v42, v42
    v_exp_f32 v43, v43
    v_exp_f32 v44, v44
    v_exp_f32 v45, v45
    v_exp_f32 v46, v46
    v_exp_f32 v47, v47
    v_exp_f32 v48, v48
    v_exp_f32 v49, v49
    v_smfmac_f32_32x32x32_bf16 v[64:79], v[136:139], v[40:47], v233
    v_exp_f32 v50, v50
    v_exp_f32 v51, v51
    v_exp_f32 v52, v52
    s_waitcnt lgkmcnt(0)
    v_mfma_f32_32x32x16_bf16 v[32:47], v[140:143], v[4:7], v[96:111]
    v_exp_f32 v53, v53
    v_exp_f32 v54, v54
    v_exp_f32 v55, v55
    v_exp_f32 v56, v56
    v_exp_f32 v57, v57
    v_smfmac_f32_32x32x32_bf16 v[80:95], v[132:135], v[48:55], v233
    v_exp_f32 v58, v58
    v_exp_f32 v59, v59
    v_exp_f32 v60, v60
    v_exp_f32 v61, v61
    v_exp_f32 v62, v62
    v_exp_f32 v63, v63
    v_exp_f32 v32, v32
    v_exp_f32 v33, v33
    v_smfmac_f32_32x32x32_bf16 v[80:95], v[136:139], v[56:63], v233
    s_waitcnt vmcnt(0)
    ds_read_b64_tr_b16 v[208:209], v236 offset:0
    ds_read_b64_tr_b16 v[210:211], v236 offset:1024
    ds_read_b64_tr_b16 v[212:213], v236 offset:64
    ds_read_b64_tr_b16 v[214:215], v236 offset:1088
    ds_read_b64_tr_b16 v[216:217], v236 offset:2048
    ds_read_b64_tr_b16 v[218:219], v236 offset:3072
    ds_read_b64_tr_b16 v[220:221], v236 offset:2112
    ds_read_b64_tr_b16 v[222:223], v236 offset:3136
    ds_read_b128 v[128:131], v232 offset:57344
    s_mov_b64 exec, s[30:31]
    ds_read_b128 v[132:135], v232 offset:58368
    ds_read_b128 v[136:139], v232 offset:58624
    s_mov_b64 exec, -1
    v_exp_f32 v34, v34
    v_exp_f32 v35, v35
    v_exp_f32 v36, v36
    v_mfma_f32_32x32x16_bf16 v[48:63], v[140:143], v[8:11], v[112:127]
    v_exp_f32 v37, v37
    v_exp_f32 v38, v38
    v_exp_f32 v39, v39
    v_exp_f32 v40, v40
    v_exp_f32 v41, v41
    v_smfmac_f32_32x32x32_bf16 v[64:79], v[144:147], v[32:39], v233
    v_exp_f32 v42, v42
    v_exp_f32 v43, v43
    v_exp_f32 v44, v44
    v_exp_f32 v45, v45
    v_exp_f32 v46, v46
    v_exp_f32 v47, v47
    v_exp_f32 v48, v48
    v_exp_f32 v49, v49
    v_smfmac_f32_32x32x32_bf16 v[64:79], v[148:151], v[40:47], v233
    v_exp_f32 v50, v50
    v_exp_f32 v51, v51
    v_exp_f32 v52, v52
    s_waitcnt lgkmcnt(0)
    v_mfma_f32_32x32x16_bf16 v[32:47], v[128:131], v[4:7], v[96:111]
    v_exp_f32 v53, v53
    v_exp_f32 v54, v54
    v_exp_f32 v55, v55
    v_exp_f32 v56, v56
    v_exp_f32 v57, v57
    v_smfmac_f32_32x32x32_bf16 v[80:95], v[144:147], v[48:55], v233
    v_cmp_ne_u32 vcc, s60, v18
    v_lshlrev_b32 v18, 2, v242
    s_cbranch_vccnz B_pslow
B_pok:
    buffer_load_dword v19, v18, s[16:19], s54 offen sc1
    v_exp_f32 v58, v58
    v_exp_f32 v59, v59
    v_exp_f32 v60, v60
    v_exp_f32 v61, v61
    v_exp_f32 v62, v62
    v_exp_f32 v63, v63
    v_exp_f32 v32, v32
    v_exp_f32 v33, v33
    v_smfmac_f32_32x32x32_bf16 v[80:95], v[148:151], v[56:63], v233
    ds_read_b128 v[140:143], v232 offset:59392
    s_mov_b64 exec, s[30:31]
    ds_read_b128 v[144:147], v232 offset:60416
    ds_read_b128 v[148:151], v232 offset:60672
    s_mov_b64 exec, -1
    v_exp_f32 v34, v34
    v_exp_f32 v35, v35
    v_exp_f32 v36, v36
    v_mfma_f32_32x32x16_bf16 v[48:63], v[128:131], v[8:11], v[112:127]
    v_exp_f32 v37, v37
    v_exp_f32 v38, v38
    v_exp_f32 v39, v39
    v_exp_f32 v40, v40
    v_exp_f32 v41, v41
    v_smfmac_f32_32x32x32_bf16 v[64:79], v[132:135], v[32:39], v233
    buffer_load_dwordx4 v[20:23], v244, s[16:19], s55 offen sc1
    v_exp_f32 v42, v42
    v_exp_f32 v43, v43
    v_exp_f32 v44, v44
    v_exp_f32 v45, v45
    v_exp_f32 v46, v46
    v_exp_f32 v47, v47
    v_exp_f32 v48, v48
    v_exp_f32 v49, v49
    v_smfmac_f32_32x32x32_bf16 v[64:79], v[136:139], v[40:47], v233
    v_exp_f32 v50, v50
    v_exp_f32 v51, v51
    v_exp_f32 v52, v52
    s_waitcnt lgkmcnt(0)
    v_mfma_f32_32x32x16_bf16 v[32:47], v[140:143], v[4:7], v[96:111]
    v_exp_f32 v53, v53
    v_exp_f32 v54, v54
    v_exp_f32 v55, v55
    v_exp_f32 v56, v56
    v_exp_f32 v57, v57
    v_smfmac_f32_32x32x32_bf16 v[80:95], v[132:135], v[48:55], v233
    buffer_load_dwordx4 v[24:27], v244, s[16:19], s55 offen offset:1024 sc1
    v_exp_f32 v58, v58
    v_exp_f32 v59, v59
    v_exp_f32 v60, v60
    v_exp_f32 v61, v61
    v_exp_f32 v62, v62
    v_exp_f32 v63, v63
    v_exp_f32 v32, v32
    v_exp_f32 v33, v33
    v_smfmac_f32_32x32x32_bf16 v[80:95], v[136:139], v[56:63], v233
    ds_read_b128 v[128:131], v232 offset:61440
    s_mov_b64 exec, s[30:31]
    ds_read_b128 v[132:135], v232 offset:62464
    ds_read_b128 v[136:139], v232 offset:62720
    s_mov_b64 exec, -1
    v_exp_f32 v34, v34
    v_exp_f32 v35, v35
    v_exp_f32 v36, v36
    v_mfma_f32_32x32x16_bf16 v[48:63], v[140:143], v[8:11], v[112:127]
    v_exp_f32 v37, v37
    v_exp_f32 v38, v38
    v_exp_f32 v39, v39
    v_exp_f32 v40, v40
    v_exp_f32 v41, v41
    v_smfmac_f32_32x32x32_bf16 v[64:79], v[144:147], v[32:39], v233
    v_exp_f32 v42, v42
    v_exp_f32 v43, v43
    v_exp_f32 v44, v44
    v_exp_f32 v45, v45
    v_exp_f32 v46, v46
    v_exp_f32 v47, v47
    v_exp_f32 v48, v48
    v_exp_f32 v49, v49
    v_smfmac_f32_32x32x32_bf16 v[64:79], v[148:151], v[40:47], v233
    v_exp_f32 v50, v50
    v_exp_f32 v51, v51
    v_exp_f32 v52, v52
    s_waitcnt lgkmcnt(0)
    v_mfma_f32_32x32x16_bf16 v[32:47], v[128:131], v[4:7], v[96:111]
    v_exp_f32 v53, v53
    v_exp_f32 v54, v54
    v_exp_f32 v55, v55
    v_exp_f32 v56, v56
    v_exp_f32 v57, v57
    v_smfmac_f32_32x32x32_bf16 v[80:95], v[144:147], v[48:55], v233
    v_exp_f32 v58, v58
    v_exp_f32 v59, v59
    v_exp_f32 v60, v60
    v_exp_f32 v61, v61
    v_exp_f32 v62, v62
    v_exp_f32 v63, v63
    v_exp_f32 v32, v32
    v_exp_f32 v33, v33
    v_smfmac_f32_32x32x32_bf16 v[80:95], v[148:151], v[56:63], v233
    ds_read_b128 v[140:143], v232 offset:63488
    s_mov_b64 exec, s[30:31]
    ds_read_b128 v[144:147], v232 offset:64512
    ds_read_b128 v[148:151], v232 offset:64768
    s_mov_b64 exec, -1
    v_exp_f32 v34, v34
    v_exp_f32 v35, v35
    v_exp_f32 v36, v36
    v_mfma_f32_32x32x16_bf16 v[48:63], v[128:131], v[8:11], v[112:127]
    v_exp_f32 v37, v37
    v_exp_f32 v38, v38
    v_exp_f32 v39, v39
    v_exp_f32 v40, v40
    v_exp_f32 v41, v41
    v_smfmac_f32_32x32x32_bf16 v[64:79], v[132:135], v[32:39], v233
    v_exp_f32 v42, v42
    v_exp_f32 v43, v43
    v_exp_f32 v44, v44
    v_exp_f32 v45, v45
    v_exp_f32 v46, v46
    v_exp_f32 v47, v47
    v_exp_f32 v48, v48
    v_exp_f32 v49, v49
    v_smfmac_f32_32x32x32_bf16 v[64:79], v[136:139], v[40:47], v233
    v_exp_f32 v50, v50
    v_exp_f32 v51, v51
    v_exp_f32 v52, v52
    s_waitcnt lgkmcnt(0)
    v_mfma_f32_32x32x16_bf16 v[32:47], v[140:143], v[4:7], v[96:111]
    v_exp_f32 v53, v53
    v_exp_f32 v54, v54
    v_exp_f32 v55, v55
    v_exp_f32 v56, v56
    v_exp_f32 v57, v57
    v_smfmac_f32_32x32x32_bf16 v[80:95], v[132:135], v[48:55], v233
    v_exp_f32 v58, v58
    v_exp_f32 v59, v59
    v_exp_f32 v60, v60
    v_exp_f32 v61, v61
    v_exp_f32 v62, v62
    v_exp_f32 v63, v63
    v_exp_f32 v32, v32
    v_exp_f32 v33, v33
    v_smfmac_f32_32x32x32_bf16 v[80:95], v[136:139], v[56:63], v233
    v_exp_f32 v34, v34
    v_exp_f32 v35, v35
    v_exp_f32 v36, v36
    v_mfma_f32_32x32x16_bf16 v[48:63], v[140:143], v[8:11], v[112:127]
    v_exp_f32 v37, v37
    v_exp_f32 v38, v38
    v_exp_f32 v39, v39
    v_exp_f32 v40, v40
    v_exp_f32 v41, v41
    v_smfmac_f32_32x32x32_bf16 v[64:79], v[144:147], v[32:39], v233
    v_exp_f32 v42, v42
    v_exp_f32 v43, v43
    v_exp_f32 v44, v44
    v_exp_f32 v45, v45
    v_exp_f32 v46, v46
    v_exp_f32 v47, v47
    v_exp_f32 v48, v48
    v_exp_f32 v49, v49
    v_smfmac_f32_32x32x32_bf16 v[64:79], v[148:151], v[40:47], v233
    v_exp_f32 v50, v50
    v_exp_f32 v51, v51
    v_exp_f32 v52, v52
    v_exp_f32 v53, v53
    v_exp_f32 v54, v54
    v_exp_f32 v55, v55
    v_exp_f32 v56, v56
    v_exp_f32 v57, v57
    v_smfmac_f32_32x32x32_bf16 v[80:95], v[144:147], v[48:55], v233
    v_exp_f32 v58, v58
    v_exp_f32 v59, v59
    v_exp_f32 v60, v60
    v_exp_f32 v61, v61
    v_exp_f32 v62, v62
    v_exp_f32 v63, v63
    s_nop 1
    v_smfmac_f32_32x32x32_bf16 v[80:95], v[148:151], v[56:63], v233
    v_add_u32 v12, s42, v224
    v_xor_b32 v17, 16384, v12
    v_mov_b32 v14, 0
    s_mov_b32 s28, 0x5d800000
    s_mov_b32 s29, 0x30800000
    v_fma_f32 v14, v64, 0, v14
    v_fma_f32 v14, v65, 0, v14
    v_fma_f32 v14, v66, 0, v14
    v_fma_f32 v14, v67, 0, v14
    v_fma_f32 v14, v68, 0, v14
    v_fma_f32 v14, v69, 0, v14
    v_fma_f32 v14, v70, 0, v14
    v_fma_f32 v14, v71, 0, v14
    v_cmp_nge_f32 s[4:5], s28, v72
    v_cmp_nle_f32 s[6:7], s29, v72
    ds_write_b128 v12, v[80:83] offset:0
    ds_write_b128 v12, v[84:87] offset:1024
    ds_write_b128 v12, v[88:91] offset:2048
    v_fma_f32 v14, v80, 0, v14
    v_fma_f32 v14, v81, 0, v14
    v_fma_f32 v14, v82, 0, v14
    v_fma_f32 v14, v83, 0, v14
    v_fma_f32 v14, v84, 0, v14
    v_fma_f32 v14, v85, 0, v14
    v_fma_f32 v14, v86, 0, v14
    v_fma_f32 v14, v87, 0, v14
    v_cmp_nge_f32 s[32:33], s28, v88
    v_cmp_nle_f32 s[50:51], s29, v88
    v_cmp_u_f32 vcc, v14, v14
    s_or_b64 s[4:5], s[4:5], s[6:7]
    s_or_b64 s[32:33], s[32:33], s[50:51]
    s_or_b64 vcc, vcc, s[4:5]
    s_or_b64 vcc, vcc, s[32:33]
    s_cselect_b32 s28, 1, 0
    v_mov_b32 v14, s28
    ds_write_b32 v12, v14 offset:3072
    v_and_b32 v15, 7, v0
    v_lshlrev_b32 v16, 12, v15
    v_add_u32 v16, 131072, v16
    s_waitcnt lgkmcnt(0)
    s_barrier
    ds_read_b32 v14, v16 offset:3072
    ds_read_b128 v[32:35], v17 offset:0
    ds_read_b128 v[36:39], v17 offset:1024
    ds_read_b128 v[40:43], v17 offset:2048
    s_waitcnt lgkmcnt(0)
    v_cmp_ne_u32 vcc, 0, v14
    v_add_f32 v72, v72, v40
    v_rcp_f32 v14, v72
    s_cmp_lg_u32 s70, 0
    s_cselect_b64 vcc, 0, vcc
    s_cbranch_vccnz B_fallback
    v_add_f32 v64, v64, v32
    v_add_f32 v65, v65, v33
    v_add_f32 v66, v66, v34
    v_add_f32 v67, v67, v35
    v_add_f32 v68, v68, v36
    v_add_f32 v69, v69, v37
    v_add_f32 v70, v70, v38
    v_add_f32 v71, v71, v39
    v_mul_f32 v64, v64, v14
    v_mul_f32 v65, v65, v14
    v_mul_f32 v66, v66, v14
    v_mul_f32 v67, v67, v14
    v_mul_f32 v68, v68, v14
    v_mul_f32 v69, v69, v14
    v_mul_f32 v70, v70, v14
    v_mul_f32 v71, v71, v14
    v_cvt_pk_bf16_f32 v28, v64, v65
    v_cvt_pk_bf16_f32 v29, v66, v67
    v_cvt_pk_bf16_f32 v30, v68, v69
    v_cvt_pk_bf16_f32 v31, v70, v71
    v_min_u32 v28, -2, v28
    v_min_u32 v29, -2, v29
    v_min_u32 v30, -2, v30
    v_min_u32 v31, -2, v31
    buffer_store_dwordx4 v[28:31], v224, s[16:19], s43 offen sc1
    s_add_u32 s6, s56, 4096
    s_barrier
    buffer_load_dwordx4 v[128:131], v224, s[16:19], s56 offen offset:0 sc1
    buffer_load_dwordx4 v[132:135], v224, s[16:19], s56 offen offset:1024 sc1
    buffer_load_dwordx4 v[136:139], v224, s[16:19], s56 offen offset:2048 sc1
    buffer_load_dwordx4 v[140:143], v224, s[16:19], s56 offen offset:3072 sc1
    buffer_load_dwordx4 v[144:147], v224, s[16:19], s6 offen offset:0 sc1
    buffer_load_dwordx4 v[148:151], v224, s[16:19], s6 offen offset:1024 sc1
    buffer_load_dwordx4 v[152:155], v224, s[16:19], s6 offen offset:2048 sc1
    buffer_load_dwordx4 v[156:159], v224, s[16:19], s6 offen offset:3072 sc1
    s_mov_b32 s71, 200000
    s_waitcnt vmcnt(9)
    v_mov_b32 v7, v19
    v_mfma_f32_32x32x16_bf16 v[64:79], v[20:23], v[246:249], 0
    v_mfma_f32_32x32x16_bf16 v[64:79], v[24:27], v[250:253], v[64:79]
    v_sub_f32 v8, 1.0, v7
    v_cvt_pk_bf16_f32 v8, v8, v8
    v_lshlrev_b32 v8, 16, v8
    s_mov_b64 s[36:37], -1
    s_mov_b64 s[38:39], -1
    s_mov_b64 s[40:41], -1
    s_mov_b64 s[42:43], -1
    s_mov_b64 s[44:45], -1
    s_mov_b64 s[46:47], -1
    s_mov_b64 s[48:49], -1
    s_mov_b64 s[50:51], -1
    s_branch C_chk
C_retry:
    s_mov_b64 exec, s[36:37]
    buffer_load_dwordx4 v[128:131], v224, s[16:19], s56 offen offset:0 sc1
    s_mov_b64 exec, s[38:39]
    buffer_load_dwordx4 v[132:135], v224, s[16:19], s56 offen offset:1024 sc1
    s_mov_b64 exec, s[40:41]
    buffer_load_dwordx4 v[136:139], v224, s[16:19], s56 offen offset:2048 sc1
    s_mov_b64 exec, s[42:43]
    buffer_load_dwordx4 v[140:143], v224, s[16:19], s56 offen offset:3072 sc1
    s_mov_b64 exec, s[44:45]
    buffer_load_dwordx4 v[144:147], v224, s[16:19], s6 offen offset:0 sc1
    s_mov_b64 exec, s[46:47]
    buffer_load_dwordx4 v[148:151], v224, s[16:19], s6 offen offset:1024 sc1
    s_mov_b64 exec, s[48:49]
    buffer_load_dwordx4 v[152:155], v224, s[16:19], s6 offen offset:2048 sc1
    s_mov_b64 exec, s[50:51]
    buffer_load_dwordx4 v[156:159], v224, s[16:19], s6 offen offset:3072 sc1
    s_mov_b64 exec, -1
C_chk:
    s_sub_u32 s71, s71, 1
    s_cselect_b64 s[30:31], 0, -1
    s_waitcnt vmcnt(7)
    v_max3_u32 v80, v128, v129, v130
    v_max_u32 v80, v80, v131
    v_cmp_eq_u32 s[36:37], -1, v80
    s_nop 1
    s_and_b64 s[28:29], s[36:37], s[30:31]
    s_cbranch_scc1 C_retry
    v_mfma_f32_32x32x16_bf16 v[32:47], v[160:163], v[128:131], 0
    v_mfma_f32_32x32x16_bf16 v[48:63], v[164:167], v[128:131], 0
    s_waitcnt vmcnt(6)
    v_max3_u32 v81, v132, v133, v134
    v_max_u32 v81, v81, v135
    v_cmp_eq_u32 s[38:39], -1, v81
    s_nop 1
    s_and_b64 s[28:29], s[38:39], s[30:31]
    s_cbranch_scc1 C_retry
    v_mfma_f32_32x32x16_bf16 v[32:47], v[168:171], v[132:135], v[32:47]
    v_mfma_f32_32x32x16_bf16 v[48:63], v[172:175], v[132:135], v[48:63]
    s_waitcnt vmcnt(5)
    v_max3_u32 v82, v136, v137, v138
    v_max_u32 v82, v82, v139
    v_cmp_eq_u32 s[40:41], -1, v82
    s_nop 1
    s_and_b64 s[28:29], s[40:41], s[30:31]
    s_cbranch_scc1 C_retry
    v_mfma_f32_32x32x16_bf16 v[32:47], v[176:179], v[136:139], v[32:47]
    v_mfma_f32_32x32x16_bf16 v[48:63], v[180:183], v[136:139], v[48:63]
    s_waitcnt vmcnt(4)
    v_max3_u32 v83, v140, v141, v142
    v_max_u32 v83, v83, v143
    v_cmp_eq_u32 s[42:43], -1, v83
    s_nop 1
    s_and_b64 s[28:29], s[42:43], s[30:31]
    s_cbranch_scc1 C_retry
    v_mfma_f32_32x32x16_bf16 v[32:47], v[184:187], v[140:143], v[32:47]
    v_mfma_f32_32x32x16_bf16 v[48:63], v[188:191], v[140:143], v[48:63]
    s_waitcnt vmcnt(3)
    v_max3_u32 v84, v144, v145, v146
    v_max_u32 v84, v84, v147
    v_cmp_eq_u32 s[44:45], -1, v84
    s_nop 1
    s_and_b64 s[28:29], s[44:45], s[30:31]
    s_cbranch_scc1 C_retry
    v_mfma_f32_32x32x16_bf16 v[32:47], v[192:195], v[144:147], v[32:47]
    v_mfma_f32_32x32x16_bf16 v[48:63], v[196:199], v[144:147], v[48:63]
    s_waitcnt vmcnt(2)
    v_max3_u32 v85, v148, v149, v150
    v_max_u32 v85, v85, v151
    v_cmp_eq_u32 s[46:47], -1, v85
    s_nop 1
    s_and_b64 s[28:29], s[46:47], s[30:31]
    s_cbranch_scc1 C_retry
    v_mfma_f32_32x32x16_bf16 v[32:47], v[200:203], v[148:151], v[32:47]
    v_mfma_f32_32x32x16_bf16 v[48:63], v[204:207], v[148:151], v[48:63]
    s_waitcnt vmcnt(1)
    v_max3_u32 v86, v152, v153, v154
    v_max_u32 v86, v86, v155
    v_cmp_eq_u32 s[48:49], -1, v86
    s_nop 1
    s_and_b64 s[28:29], s[48:49], s[30:31]
    s_cbranch_scc1 C_retry
    v_mfma_f32_32x32x16_bf16 v[32:47], v[208:211], v[152:155], v[32:47]
    v_mfma_f32_32x32x16_bf16 v[48:63], v[212:215], v[152:155], v[48:63]
    s_waitcnt vmcnt(0)
    v_max3_u32 v87, v156, v157, v158
    v_max_u32 v87, v87, v159
    v_cmp_eq_u32 s[50:51], -1, v87
    s_nop 1
    s_and_b64 s[28:29], s[50:51], s[30:31]
    s_cbranch_scc1 C_retry
    v_mfma_f32_32x32x16_bf16 v[32:47], v[216:219], v[156:159], v[32:47]
    v_mfma_f32_32x32x16_bf16 v[48:63], v[220:223], v[156:159], v[48:63]
    v_mul_f32 v64, v64, v8
    v_mul_f32 v65, v65, v8
    v_mul_f32 v66, v66, v8
    v_mul_f32 v67, v67, v8
    v_mul_f32 v68, v68, v8
    v_mul_f32 v69, v69, v8
    v_mul_f32 v70, v70, v8
    v_mul_f32 v71, v71, v8
    s_nop 2
    ds_write_b128 v228, v[32:35] offset:0
    ds_write_b128 v228, v[36:39] offset:1024
    ds_write_b128 v228, v[40:43] offset:8192
    ds_write_b128 v228, v[44:47] offset:9216
    ds_write_b128 v228, v[48:51] offset:16384
    ds_write_b128 v228, v[52:55] offset:17408
    ds_write_b128 v228, v[56:59] offset:24576
    ds_write_b128 v228, v[60:63] offset:25600
    s_waitcnt lgkmcnt(0)
    s_barrier
    ds_read_b128 v[80:83], v229 offset:0
    ds_read_b128 v[84:87], v229 offset:1024
    ds_read_b128 v[88:91], v229 offset:2048
    ds_read_b128 v[92:95], v229 offset:3072
    ds_read_b128 v[96:99], v229 offset:4096
    ds_read_b128 v[100:103], v229 offset:5120
    ds_read_b128 v[104:107], v229 offset:6144
    ds_read_b128 v[108:111], v229 offset:7168
    s_waitcnt lgkmcnt(4)
    v_add_f32 v80, v80, v88
    v_add_f32 v81, v81, v89
    v_add_f32 v82, v82, v90
    v_add_f32 v83, v83, v91
    v_add_f32 v84, v84, v92
    v_add_f32 v85, v85, v93
    v_add_f32 v86, v86, v94
    v_add_f32 v87, v87, v95
    s_waitcnt lgkmcnt(0)
    v_add_f32 v96, v96, v104
    v_add_f32 v97, v97, v105
    v_add_f32 v98, v98, v106
    v_add_f32 v99, v99, v107
    v_add_f32 v100, v100, v108
    v_add_f32 v101, v101, v109
    v_add_f32 v102, v102, v110
    v_add_f32 v103, v103, v111
    v_add_f32 v80, v80, v96
    v_add_f32 v81, v81, v97
    v_add_f32 v82, v82, v98
    v_add_f32 v83, v83, v99
    v_add_f32 v84, v84, v100
    v_add_f32 v85, v85, v101
    v_add_f32 v86, v86, v102
    v_add_f32 v87, v87, v103
    v_fma_f32 v80, v80, v7, v64
    v_fma_f32 v81, v81, v7, v65
    v_fma_f32 v82, v82, v7, v66
    v_fma_f32 v83, v83, v7, v67
    v_fma_f32 v84, v84, v7, v68
    v_fma_f32 v85, v85, v7, v69
    v_fma_f32 v86, v86, v7, v70
    v_fma_f32 v87, v87, v7, v71
    v_cvt_pk_bf16_f32 v12, v80, v81
    v_cvt_pk_bf16_f32 v13, v82, v83
    v_cvt_pk_bf16_f32 v14, v84, v85
    v_cvt_pk_bf16_f32 v15, v86, v87
    s_nop 0
    v_permlane32_swap_b32 v12, v14
    v_permlane32_swap_b32 v13, v15
    buffer_store_dwordx4 v[12:15], v245, s[20:23], s57 offen
    s_or_b32 s28, s2, s3
    s_cmp_lg_u32 s28, 0
    s_cbranch_scc1 L_fin
    s_mov_b32 s28, 15794176
    v_mov_b32 v6, 0
    v_mov_b32 v7, s60
    s_mov_b64 exec, 1
    buffer_store_dword v7, v6, s[16:19], s28 offen sc1
    s_mov_b64 exec, -1
L_fin:
L_end:
    s_endpgm
B_pslow:
    s_mov_b32 s71, 200000
SP3:
    s_sleep 2
    buffer_load_dword v19, v241, s[16:19], 0 offen sc1
SP3_chk:
    s_waitcnt vmcnt(0)
    v_cmp_ne_u32 vcc, s60, v19
    s_sub_u32 s71, s71, 1
    s_nop 0
    s_cselect_b64 vcc, 0, vcc
    s_cbranch_vccnz SP3
    s_branch B_pok
B_fallback:
    s_barrier
    s_mov_b32 s70, 1
    s_mov_b32 s28, 64
    v_mov_b32 v12, v224
    v_mov_b32 v16, 0xff800000
    v_mov_b32 v17, 0xff800000
B_maxloop:
    ds_read_b128 v[128:131], v12
    v_add_u32 v12, 2048, v12
    s_waitcnt lgkmcnt(0)
    v_mfma_f32_32x32x16_bf16 v[32:47], v[128:131], v[4:7], 0
    v_mfma_f32_32x32x16_bf16 v[48:63], v[128:131], v[8:11], 0
    s_sub_u32 s28, s28, 1
    s_cmp_lg_u32 s28, 0
    s_nop 8
    v_max3_f32 v16, v16, v32, v33
    v_max3_f32 v16, v16, v34, v35
    v_max3_f32 v16, v16, v36, v37
    v_max3_f32 v16, v16, v38, v39
    v_max3_f32 v16, v16, v40, v41
    v_max3_f32 v16, v16, v42, v43
    v_max3_f32 v16, v16, v44, v45
    v_max3_f32 v16, v16, v46, v47
    v_max3_f32 v17, v17, v48, v49
    v_max3_f32 v17, v17, v50, v51
    v_max3_f32 v17, v17, v52, v53
    v_max3_f32 v17, v17, v54, v55
    v_max3_f32 v17, v17, v56, v57
    v_max3_f32 v17, v17, v58, v59
    v_max3_f32 v17, v17, v60, v61
    v_max3_f32 v17, v17, v62, v63
    s_cbranch_scc1 B_maxloop
    v_mov_b32 v15, v16
    s_nop 1
    v_permlane32_swap_b32 v16, v15
    v_max_f32 v15, v16, v15
    v_sub_f32 v15, 0, v15
    v_mov_b32 v96, v15
    v_mov_b32 v97, v15
    v_mov_b32 v98, v15
    v_mov_b32 v99, v15
    v_mov_b32 v100, v15
    v_mov_b32 v101, v15
    v_mov_b32 v102, v15
    v_mov_b32 v103, v15
    v_mov_b32 v104, v15
    v_mov_b32 v105, v15
    v_mov_b32 v106, v15
    v_mov_b32 v107, v15
    v_mov_b32 v108, v15
    v_mov_b32 v109, v15
    v_mov_b32 v110, v15
    v_mov_b32 v111, v15
    v_mov_b32 v15, v17
    s_nop 1
    v_permlane32_swap_b32 v17, v15
    v_max_f32 v15, v17, v15
    v_sub_f32 v15, 0, v15
    v_mov_b32 v112, v15
    v_mov_b32 v113, v15
    v_mov_b32 v114, v15
    v_mov_b32 v115, v15
    v_mov_b32 v116, v15
    v_mov_b32 v117, v15
    v_mov_b32 v118, v15
    v_mov_b32 v119, v15
    v_mov_b32 v120, v15
    v_mov_b32 v121, v15
    v_mov_b32 v122, v15
    v_mov_b32 v123, v15
    v_mov_b32 v124, v15
    v_mov_b32 v125, v15
    v_mov_b32 v126, v15
    v_mov_b32 v127, v15
    v_mov_b32 v64, 0
    v_mov_b32 v65, 0
    v_mov_b32 v66, 0
    v_mov_b32 v67, 0
    v_mov_b32 v68, 0
    v_mov_b32 v69, 0
    v_mov_b32 v70, 0
    v_mov_b32 v71, 0
    v_mov_b32 v72, 0
    v_mov_b32 v73, 0
    v_mov_b32 v74, 0
    v_mov_b32 v75, 0
    v_mov_b32 v76, 0
    v_mov_b32 v77, 0
    v_mov_b32 v78, 0
    v_mov_b32 v79, 0
    v_mov_b32 v80, 0
    v_mov_b32 v81, 0
    v_mov_b32 v82, 0
    v_mov_b32 v83, 0
    v_mov_b32 v84, 0
    v_mov_b32 v85, 0
    v_mov_b32 v86, 0
    v_mov_b32 v87, 0
    v_mov_b32 v88, 0
    v_mov_b32 v89, 0
    v_mov_b32 v90, 0
    v_mov_b32 v91, 0
    v_mov_b32 v92, 0
    v_mov_b32 v93, 0
    v_mov_b32 v94, 0
    v_mov_b32 v95, 0
    ds_read_b128 v[128:131], v232 offset:0
    s_mov_b64 exec, s[30:31]
    ds_read_b128 v[132:135], v232 offset:1024
    ds_read_b128 v[136:139], v232 offset:1280
    s_mov_b64 exec, -1
    s_waitcnt lgkmcnt(0)
    v_mfma_f32_32x32x16_bf16 v[32:47], v[128:131], v[4:7], v[96:111]
    s_nop 7
    s_branch B_go
L_codeend:
.section .rodata,"a"
.p2align 6
.amdhsa_kernel gated_mix__softmax_full_mha__ssm_conv_s4__prompt_kernel
  .amdhsa_next_free_vgpr 256
  .amdhsa_next_free_sgpr 74
  .amdhsa_accum_offset 256
  .amdhsa_group_segment_fixed_size 0
  .amdhsa_kernarg_size 128
  .amdhsa_user_sgpr_count 2
  .amdhsa_user_sgpr_kernarg_segment_ptr 1
  .amdhsa_system_sgpr_workgroup_id_x 1
.end_amdhsa_kernel
```
